```python
import torch

def _softmax(x, axis=-1):
    return torch.softmax(x, dim=axis)
def _gelu(x):
    return torch.nn.functional.gelu(x, approximate="tanh")
def _silu(x):
    return torch.nn.functional.silu(x)
def _sigmoid(x):
    return torch.sigmoid(x)
def _layernorm(x, axis=-1, eps=1e-5):
    m = x.mean(dim=axis, keepdim=True)
    v = x.var(dim=axis, keepdim=True, unbiased=False)
    return (x - m) / torch.sqrt(v + eps)
def _scatter_add(tgt, idx, src, axis=0):
    return tgt.clone().index_add_(axis, idx, src)
def _segment_sum(src, seg, n):
    out = torch.zeros((n,) + src.shape[1:], dtype=src.dtype)
    return out.index_add_(0, seg, src)
def _pad(x, pw):
    flat = tuple(v for pair in reversed(pw) for v in pair)
    return torch.nn.functional.pad(x, flat)

kernel_name = 'parallel_sum__linear_kernel_hedgehog__mixer_token_mlp__prompt'

def setup_inputs():

    _w = (lambda a: (lambda t: t.to(torch.bfloat16) if t.is_floating_point() else t)(torch.as_tensor(a)))
    def _A_setup():
        B, S, D, H = 1, 2048, 512, 32
        Dh = D // H
        return {
            "x": _w((lambda *s: torch.randn(*s, dtype=torch.bfloat16) * 0.05)(B, S, D)),
            "wqkv": _w((lambda *s: torch.randn(*s, dtype=torch.bfloat16) * 0.2)(D, 3 * D)),
            "w_phi": _w((lambda *s: torch.randn(*s, dtype=torch.bfloat16) * 0.2)(H, Dh, Dh) * (Dh ** -0.5)),
            "wo": _w((lambda *s: torch.randn(*s, dtype=torch.bfloat16) * 0.05)(D, D)),
        }
    _A_in = _A_setup()

    def _B_setup():
        B, S, D, F = 1, 2048, 512, 1376
        return {
            "x": _w((lambda *s: torch.randn(*s, dtype=torch.bfloat16) * 0.05)(B, S, D)),
            "w1": _w((lambda *s: torch.randn(*s, dtype=torch.bfloat16) * 0.8)(S, F) * (S ** -0.5)),
            "b1": _w((lambda *s: torch.randn(*s, dtype=torch.bfloat16) * 3.2)(F) * 0.02),
            "w2": _w((lambda *s: torch.randn(*s, dtype=torch.bfloat16) * 0.4)(F, S) * (F ** -0.5)),
            "b2": _w((lambda *s: torch.randn(*s, dtype=torch.bfloat16) * 1.6)(S) * 0.02),
        }
    _B_in = _B_setup()

    return {
        "A_x": _A_in["x"],
        "A_wqkv": _A_in["wqkv"],
        "A_w_phi": _A_in["w_phi"],
        "A_wo": _A_in["wo"],
        "B_x": _B_in["x"],
        "B_w1": _B_in["w1"],
        "B_b1": _B_in["b1"],
        "B_w2": _B_in["w2"],
        "B_b2": _B_in["b2"],
    }

def reference(A_x, A_wqkv, A_w_phi, A_wo, B_x, B_w1, B_b1, B_w2, B_b2):
    def _A_ref(x, wqkv, w_phi, wo):
        B, S, D = x.shape
        H = 32; Dh = D // H
        qkv = (lambda x, *d: x.permute(*d))((x @ wqkv).reshape(B, S, 3, H, Dh), 2, 0, 3, 1, 4)
        q, k, v = qkv[0], qkv[1], qkv[2]
        pq = torch.einsum("bhsd,hdf->bhsf", q, w_phi)
        pk = torch.einsum("bhsd,hdf->bhsf", k, w_phi)
        phi_q = torch.concatenate([_softmax(pq, axis=-1), _softmax(-pq, axis=-1)], axis=-1)
        phi_k = torch.concatenate([_softmax(pk, axis=-1), _softmax(-pk, axis=-1)], axis=-1)
        kv = torch.einsum("bhsf,bhsd->bhfd", phi_k, v)
        z  = torch.einsum("bhsf->bhf", phi_k)
        num = torch.einsum("bhqf,bhfd->bhqd", phi_q, kv)
        den = torch.einsum("bhqf,bhf->bhq", phi_q, z)[..., None] + 1e-6
        o = num / den
        return (lambda x, *d: x.permute(*d))(o, 0, 2, 1, 3).reshape(B, S, D) @ wo

    def _B_ref(x, w1, b1, w2, b2):
        B, S, D = x.shape
        h = _layernorm(x, axis=-1)
        u = torch.einsum("bsd,sf->bdf", h, w1) + b1
        u = _gelu(u)
        y = torch.einsum("bdf,fs->bds", u, w2) + b2
        return (lambda x, *d: x.permute(*d))(y, 0, 2, 1)

    x = A_x
    xn = _layernorm(x, axis=-1)
    return x + _A_ref(xn, A_wqkv, A_w_phi, A_wo) + _B_ref(xn, B_w1, B_b1, B_w2, B_b2)
```

```asm
; @launch grid=(256,1,1) block=(512,1,1) lds=163840
.amdgcn_target "amdgcn-amd-amdhsa--gfx950"
.text
.globl parallel_sum__linear_kernel_hedgehog__mixer_token_mlp__prompt_kernel
.p2align 8
.type parallel_sum__linear_kernel_hedgehog__mixer_token_mlp__prompt_kernel,@function
parallel_sum__linear_kernel_hedgehog__mixer_token_mlp__prompt_kernel:
    s_load_dwordx16 s[4:19], s[0:1], 0
    s_load_dwordx8 s[20:27], s[0:1], 64
    s_cmp_ge_u32 s2, 256
    s_cbranch_scc1 L_done
    s_getpc_b64 s[52:53]
    s_mov_b32 s54, 4096
    s_mov_b32 s55, 0x20000
    v_lshlrev_b32 v1, 7, v0
    buffer_load_dword v2, v1, s[52:55], 0 offen
    s_and_b32 s64, s2, 7
    s_lshr_b32 s65, s2, 3
    v_and_b32 v210, 7, v0
    s_lshr_b32 s29, s64, 1
    s_lshl_b32 s29, s29, 3
    v_lshrrev_b32 v212, 3, v0
    s_and_b32 s72, s65, 7
    s_add_u32 s29, s29, s72
    s_lshr_b32 s66, s65, 3
    s_lshl_b32 s67, s66, 4
    v_add_u32 v211, s67, v212
    v_and_b32 v211, 63, v211
    s_and_b32 s30, s64, 1
    v_lshlrev_b32 v5, 10, v211
    s_lshl_b32 s30, s30, 2
    v_lshl_add_u32 v5, v210, 4, v5
    s_add_u32 s30, s30, s66
    v_lshrrev_b32 v6, 6, v0
    s_lshl_b32 s69, s29, 16
    v_add_u32 v5, s69, v5
    s_lshl_b32 s64, s30, 7
    v_readfirstlane_b32 s28, v6
    s_getpc_b64 s[52:53]
L_pc:
    s_lshl_b32 s65, s2, 3
    s_add_u32 s65, s65, L_table-L_pc
    s_mov_b32 s86, 0x200000
    s_mov_b32 s87, 0x20000
    s_waitcnt lgkmcnt(0)
    s_mov_b32 s84, s4
    s_mov_b32 s85, s5
    s_load_dwordx2 s[94:95], s[52:53], s65
    v_bfe_u32 v6, v0, 4, 1
    v_lshlrev_b32 v6, 2, v6
    v_xor_b32 v6, v6, v210
    v_and_b32 v212, 7, v212
    v_mul_u32_u24 v185, 3072, v212
    v_lshl_add_u32 v185, v6, 4, v185
    v_add_u32 v185, s64, v185
    s_mov_b32 s40, s6
    s_mov_b32 s41, s7
    s_mov_b32 s42, 0x180000
    s_mov_b32 s43, 0x20000
    v_mov_b32 v213, v5
    s_cmp_ge_u32 s28, 8
    s_cbranch_scc1 xl_1
    s_lshl_b32 s64, s30, 7
    buffer_load_dwordx4 v[36:39], v213, s[84:87], s64 offen
    s_add_u32 s64, s64, 128
    s_and_b32 s64, s64, 1023
    buffer_load_dwordx4 v[40:43], v213, s[84:87], s64 offen
    s_add_u32 s64, s64, 128
    s_and_b32 s64, s64, 1023
    buffer_load_dwordx4 v[44:47], v213, s[84:87], s64 offen
    s_add_u32 s64, s64, 128
    s_and_b32 s64, s64, 1023
    buffer_load_dwordx4 v[48:51], v213, s[84:87], s64 offen
    s_add_u32 s64, s64, 128
    s_and_b32 s64, s64, 1023
    buffer_load_dwordx4 v[52:55], v213, s[84:87], s64 offen
    s_add_u32 s64, s64, 128
    s_and_b32 s64, s64, 1023
    buffer_load_dwordx4 v[56:59], v213, s[84:87], s64 offen
    s_add_u32 s64, s64, 128
    s_and_b32 s64, s64, 1023
    buffer_load_dwordx4 v[60:63], v213, s[84:87], s64 offen
    s_add_u32 s64, s64, 128
    s_and_b32 s64, s64, 1023
    buffer_load_dwordx4 v[64:67], v213, s[84:87], s64 offen
xl_1:
    v_and_b32 v4, 63, v0
    s_cmp_lg_u32 s28, 7
    s_cbranch_scc1 cpf_2
    s_mov_b32 s54, L_done-L_pc
    s_mov_b32 s55, 0x20000
    s_bfe_u32 s64, s2, 0x30003
    s_lshl_b32 s64, s64, 13
    v_lshlrev_b32 v6, 7, v4
    buffer_load_dword v26, v6, s[52:55], s64 offen
cpf_2:
    s_mov_b32 s60, s24
    s_mov_b32 s61, s25
    s_mov_b32 s62, 0x100
    s_mov_b32 s63, 0x20000
    s_lshl_b32 s64, s2, 3
    s_add_u32 s64, s64, s28
    s_cmp_lg_u32 s64, 6
    s_cbranch_scc1 tg_3
    s_memrealtime s[92:93]
    s_waitcnt lgkmcnt(0)
    s_or_b32 s92, s92, 1
    s_mov_b64 exec, 1
    v_mov_b32 v180, s92
    v_mov_b32 v181, 0
    buffer_store_dword v180, v181, s[60:63], 0 offen sc1
    s_mov_b64 exec, -1
tg_3:
    s_lshr_b32 s65, s28, 1
    s_lshl_b32 s65, s65, 10
    s_and_b32 s64, s28, 1
    s_mul_i32 s64, s64, 98304
    s_add_u32 s64, s64, s65
    v_add_u32 v185, s64, v185
    s_lshl_b32 s70, s28, 12
    s_mov_b32 s56, s26
    s_mov_b32 s57, s27
    s_mov_b32 s58, 0x2000000
    s_mov_b32 s59, 0x20000
    v_lshrrev_b32 v10, 5, v4
    v_lshrrev_b32 v11, 4, v4
    v_bfe_u32 v12, v4, 2, 2
    v_and_b32 v13, 3, v4
    v_lshlrev_b32 v14, 4, v4
    s_and_b32 s77, s28, 3
    s_lshr_b32 s96, s67, 3
    s_add_u32 s96, s96, s28
    s_and_b32 s97, s96, 3
    s_bfe_u32 s98, s96, 0x10002
    s_lshr_b32 s66, s28, 2
    v_and_b32 v5, 31, v211
    v_xor_b32 v5, v5, v210
    v_lshlrev_b32 v5, 4, v5
    v_lshl_add_u32 v5, v210, 9, v5
    s_lshl_b32 s69, s98, 15
    s_add_u32 s69, s69, 98304
    v_add_u32 v214, s69, v5
    v_lshrrev_b32 v5, 1, v13
    v_lshl_add_u32 v5, v11, 1, v5
    s_lshl_b32 s64, s97, 3
    s_sub_u32 s91, s30, s72
    s_and_b32 s65, s91, 7
    s_lshl_b32 s65, s65, 12
    s_add_u32 s65, s65, s69
    v_and_b32 v8, 1, v13
    v_lshlrev_b32 v8, 3, v8
    v_lshl_add_u32 v8, v5, 9, v8
    v_add_u32 v8, s65, v8
    v_add_u32 v6, s64, v12
    v_xor_b32 v6, v6, v5
    v_lshl_add_u32 v215, v6, 4, v8
    v_xor_b32 v6, 4, v6
    v_lshl_add_u32 v216, v6, 4, v8
    v_and_b32 v5, 15, v4
    v_lshlrev_b32 v5, 4, v5
    v_lshl_add_u32 v5, v11, 10, v5
    s_lshl_b32 s64, s29, 1
    s_add_u32 s64, s64, s98
    s_lshl_b32 s64, s64, 15
    s_lshl_b32 s65, s30, 12
    s_add_u32 s64, s64, s65
    s_lshl_b32 s65, s97, 8
    s_add_u32 s64, s64, s65
    v_add_u32 v217, s64, v5
    v_mov_b32 v16, 0
    v_mov_b32 v17, 0
    v_mov_b32 v18, 0
    v_mov_b32 v19, 0
    s_mov_b32 s65, 0x3f803f80
    v_mov_b32 v218, 0
    v_mov_b32 v219, 0
    v_mov_b32 v220, 0
    v_mov_b32 v221, 0
    s_waitcnt lgkmcnt(0)
    s_and_b32 s31, s94, 31
    s_bfe_u32 s32, s94, 0x40005
    s_bfe_u32 s35, s94, 0x10009
    s_bfe_u32 s73, s94, 0x4000a
    s_bfe_u32 s33, s94, 0x5000e
    s_bfe_u32 s34, s94, 0x30013
    s_bfe_u32 s74, s94, 0x20016
    s_bfe_u32 s75, s94, 0x40018
    s_lshl_b32 s88, s77, 4
    s_lshl_b32 s89, s77, 12
    s_mov_b32 s76, 0x3fb8aa3b
    s_lshl_b32 s78, s30, 1
    s_and_b32 s68, s28, 1
    s_add_u32 s78, s78, s68
    s_lshl_b32 s71, s31, 7
    v_lshrrev_b32 v225, 3, v4
    v_mul_u32_u24 v225, 2752, v225
    v_add_u32 v225, s71, v225
    v_and_b32 v226, 1, v11
    v_lshlrev_b32 v226, 1, v226
    v_and_b32 v227, 7, v4
    v_xor_b32 v226, v226, v227
    v_lshl_add_u32 v20, v226, 4, v225
    v_xor_b32 v226, 4, v226
    v_lshl_add_u32 v21, v226, 4, v225
    v_add_u32 v21, 22016, v21
    v_bfe_u32 v25, v4, 2, 1
    v_bfe_u32 v226, v4, 3, 2
    v_lshl_add_u32 v226, v226, 2, v13
    v_lshlrev_b32 v226, 1, v226
    v_lshl_add_u32 v226, v10, 7, v226
    v_lshl_add_u32 v226, v25, 9, v226
    s_lshl_b32 s92, s78, 10
    v_add_u32 v190, s92, v226
    s_mov_b32 s44, s8
    s_mov_b32 s45, s9
    s_mov_b32 s46, 0x4000
    s_mov_b32 s47, 0x20000
    v_mov_b32 v22, 147456
    v_mov_b32 v23, 1
    v_lshrrev_b32 v225, 1, v4
    v_and_b32 v226, 1, v4
    v_lshlrev_b32 v226, 4, v226
    v_lshl_add_u32 v184, v225, 7, v226
    s_mov_b32 s93, 12845056
    s_mul_i32 s92, s77, 12288
    s_add_u32 s92, s92, 98304
    v_add_u32 v24, s92, v14
    s_lshl_b32 s92, s77, 5
    s_add_u32 s71, s71, s92
    v_lshlrev_b32 v225, 3, v11
    v_add_u32 v209, s71, v225
    s_mul_i32 s71, s32, 3072
    v_add_u32 v200, s71, v14
    v_lshrrev_b32 v225, 1, v12
    v_and_b32 v226, 1, v11
    v_lshl_or_b32 v225, v226, 1, v225
    v_lshl_add_u32 v226, v11, 3, v12
    v_lshlrev_b32 v226, 7, v226
    v_lshl_add_u32 v226, v13, 3, v226
    v_add_u32 v226, s89, v226
    v_xor_b32 v227, 0, v225
    v_lshl_add_u32 v201, v227, 5, v226
    v_add_u32 v205, 0x10000, v201
    v_xor_b32 v227, 1, v225
    v_lshl_add_u32 v202, v227, 5, v226
    v_add_u32 v206, 0x10000, v202
    v_xor_b32 v227, 2, v225
    v_lshl_add_u32 v203, v227, 5, v226
    v_add_u32 v207, 0x10000, v203
    v_xor_b32 v227, 3, v225
    v_lshl_add_u32 v204, v227, 5, v226
    v_add_u32 v208, 0x10000, v204
    v_and_b32 v225, 1, v11
    v_lshlrev_b32 v225, 2, v225
    v_and_b32 v226, 7, v4
    v_xor_b32 v225, v225, v226
    v_lshlrev_b32 v225, 4, v225
    v_lshrrev_b32 v226, 3, v4
    s_lshl_b32 s71, s34, 7
    v_lshl_add_u32 v192, v226, 10, v225
    v_add_u32 v192, s71, v192
    s_lshl_b32 s71, s33, 7
    v_lshl_add_u32 v193, v226, 12, v225
    v_add_u32 v193, s71, v193
    v_and_b32 v225, 1, v11
    v_lshlrev_b32 v225, 1, v225
    v_lshrrev_b32 v226, 1, v12
    v_lshl_add_u32 v225, v226, 2, v225
    v_lshl_add_u32 v226, v10, 2, v12
    v_lshlrev_b32 v226, 7, v226
    v_lshl_add_u32 v226, v13, 3, v226
    v_add_u32 v226, s89, v226
    v_lshl_add_u32 v194, v225, 4, v226
    v_xor_b32 v225, 4, v225
    v_lshl_add_u32 v195, v225, 4, v226
    v_add_u32 v196, 0x10000, v194
    v_add_u32 v197, 0x10000, v195
    v_add_u32 v198, 0x20000, v194
    v_add_u32 v199, 0x20000, v195
    s_mov_b32 s52, s10
    s_mov_b32 s53, s11
    s_mov_b32 s54, 0x80000
    s_mov_b32 s55, 0x20000
    s_mov_b32 s36, s18
    s_mov_b32 s37, s19
    s_mov_b32 s38, 0x560000
    s_mov_b32 s39, 0x20000
    s_cmp_lt_u32 s28, 4
    s_cselect_b32 s90, s35, 2
    s_bfe_u32 s67, s28, 0x10001
    s_and_b32 s68, s28, 1
    v_and_b32 v5, 31, v4
    s_lshl_b32 s64, s66, 2
    s_lshl_b32 s65, s67, 15
    s_add_u32 s65, s65, 98304
    v_add_u32 v6, s64, v10
    v_xor_b32 v8, v5, v6
    v_lshlrev_b32 v8, 4, v8
    v_lshl_add_u32 v8, v6, 9, v8
    v_add_u32 v186, s65, v8
    v_add_u32 v6, 2, v6
    v_xor_b32 v8, v5, v6
    v_lshlrev_b32 v8, 4, v8
    v_lshl_add_u32 v8, v6, 9, v8
    v_add_u32 v187, s65, v8
    v_and_b32 v5, 1, v11
    v_lshlrev_b32 v5, 1, v5
    s_lshl_b32 s64, s68, 2
    v_add_u32 v5, s64, v5
    v_lshrrev_b32 v6, 1, v12
    v_lshlrev_b32 v6, 2, v6
    v_xor_b32 v5, v5, v6
    v_lshlrev_b32 v5, 4, v5
    v_lshl_add_u32 v5, v13, 3, v5
    v_lshl_add_u32 v6, v10, 3, v12
    v_lshl_add_u32 v5, v6, 7, v5
    s_lshl_b32 s64, s66, 12
    v_add_u32 v188, s64, v5
    v_add_u32 v189, 49152, v188
    s_cmp_lt_u32 s28, 8
    s_cbranch_scc1 xl_4
    s_lshl_b32 s64, s30, 7
    buffer_load_dwordx4 v[36:39], v213, s[84:87], s64 offen
    s_add_u32 s64, s64, 128
    s_and_b32 s64, s64, 1023
    buffer_load_dwordx4 v[40:43], v213, s[84:87], s64 offen
    s_add_u32 s64, s64, 128
    s_and_b32 s64, s64, 1023
    buffer_load_dwordx4 v[44:47], v213, s[84:87], s64 offen
    s_add_u32 s64, s64, 128
    s_and_b32 s64, s64, 1023
    buffer_load_dwordx4 v[48:51], v213, s[84:87], s64 offen
    s_add_u32 s64, s64, 128
    s_and_b32 s64, s64, 1023
    buffer_load_dwordx4 v[52:55], v213, s[84:87], s64 offen
    s_add_u32 s64, s64, 128
    s_and_b32 s64, s64, 1023
    buffer_load_dwordx4 v[56:59], v213, s[84:87], s64 offen
    s_add_u32 s64, s64, 128
    s_and_b32 s64, s64, 1023
    buffer_load_dwordx4 v[60:63], v213, s[84:87], s64 offen
    s_add_u32 s64, s64, 128
    s_and_b32 s64, s64, 1023
    buffer_load_dwordx4 v[64:67], v213, s[84:87], s64 offen
xl_4:
    s_mov_b32 s65, 0x3f803f80
    s_waitcnt vmcnt(6)
    v_dot2c_f32_bf16 v218, s65, v36
    v_dot2c_f32_bf16 v220, v36, v36
    v_dot2c_f32_bf16 v219, s65, v37
    v_dot2c_f32_bf16 v221, v37, v37
    v_dot2c_f32_bf16 v218, s65, v38
    v_dot2c_f32_bf16 v220, v38, v38
    v_dot2c_f32_bf16 v219, s65, v39
    v_dot2c_f32_bf16 v221, v39, v39
    v_dot2c_f32_bf16 v218, s65, v40
    v_dot2c_f32_bf16 v220, v40, v40
    v_dot2c_f32_bf16 v219, s65, v41
    v_dot2c_f32_bf16 v221, v41, v41
    v_dot2c_f32_bf16 v218, s65, v42
    v_dot2c_f32_bf16 v220, v42, v42
    v_dot2c_f32_bf16 v219, s65, v43
    v_dot2c_f32_bf16 v221, v43, v43
    s_waitcnt vmcnt(4)
    v_dot2c_f32_bf16 v218, s65, v44
    v_dot2c_f32_bf16 v220, v44, v44
    v_dot2c_f32_bf16 v219, s65, v45
    v_dot2c_f32_bf16 v221, v45, v45
    v_dot2c_f32_bf16 v218, s65, v46
    v_dot2c_f32_bf16 v220, v46, v46
    v_dot2c_f32_bf16 v219, s65, v47
    v_dot2c_f32_bf16 v221, v47, v47
    v_dot2c_f32_bf16 v218, s65, v48
    v_dot2c_f32_bf16 v220, v48, v48
    v_dot2c_f32_bf16 v219, s65, v49
    v_dot2c_f32_bf16 v221, v49, v49
    v_dot2c_f32_bf16 v218, s65, v50
    v_dot2c_f32_bf16 v220, v50, v50
    v_dot2c_f32_bf16 v219, s65, v51
    v_dot2c_f32_bf16 v221, v51, v51
    s_waitcnt vmcnt(2)
    v_dot2c_f32_bf16 v218, s65, v52
    v_dot2c_f32_bf16 v220, v52, v52
    v_dot2c_f32_bf16 v219, s65, v53
    v_dot2c_f32_bf16 v221, v53, v53
    v_dot2c_f32_bf16 v218, s65, v54
    v_dot2c_f32_bf16 v220, v54, v54
    v_dot2c_f32_bf16 v219, s65, v55
    v_dot2c_f32_bf16 v221, v55, v55
    v_dot2c_f32_bf16 v218, s65, v56
    v_dot2c_f32_bf16 v220, v56, v56
    v_dot2c_f32_bf16 v219, s65, v57
    v_dot2c_f32_bf16 v221, v57, v57
    v_dot2c_f32_bf16 v218, s65, v58
    v_dot2c_f32_bf16 v220, v58, v58
    v_dot2c_f32_bf16 v219, s65, v59
    v_dot2c_f32_bf16 v221, v59, v59
    s_waitcnt vmcnt(0)
    v_dot2c_f32_bf16 v218, s65, v60
    v_dot2c_f32_bf16 v220, v60, v60
    v_dot2c_f32_bf16 v219, s65, v61
    v_dot2c_f32_bf16 v221, v61, v61
    v_dot2c_f32_bf16 v218, s65, v62
    v_dot2c_f32_bf16 v220, v62, v62
    v_dot2c_f32_bf16 v219, s65, v63
    v_dot2c_f32_bf16 v221, v63, v63
    v_dot2c_f32_bf16 v218, s65, v64
    v_dot2c_f32_bf16 v220, v64, v64
    v_dot2c_f32_bf16 v219, s65, v65
    v_dot2c_f32_bf16 v221, v65, v65
    v_dot2c_f32_bf16 v218, s65, v66
    v_dot2c_f32_bf16 v220, v66, v66
    v_dot2c_f32_bf16 v219, s65, v67
    v_dot2c_f32_bf16 v221, v67, v67
    s_cmp_ge_u32 s28, 6
    s_cbranch_scc1 dw_5
    s_add_u32 s64, s72, 0
    s_and_b32 s64, s64, 7
    s_mul_i32 s64, s64, 196608
    s_add_u32 m0, s70, 0
    s_nop 0
    buffer_load_dwordx4 v185, s[40:43], s64 offen lds
    s_add_u32 m0, s70, 1024
    s_add_u32 s64, s64, 24576
    buffer_load_dwordx4 v185, s[40:43], s64 offen lds
    s_add_u32 m0, s70, 2048
    s_add_u32 s64, s64, 24576
    buffer_load_dwordx4 v185, s[40:43], s64 offen lds
    s_add_u32 m0, s70, 3072
    s_add_u32 s64, s64, 24576
    buffer_load_dwordx4 v185, s[40:43], s64 offen lds
dw_5:
    v_lshlrev_b32 v68, 16, v36
    v_and_b32 v69, 0xffff0000, v36
    v_lshlrev_b32 v70, 16, v37
    v_and_b32 v71, 0xffff0000, v37
    v_add_f32 v218, v218, v219
    v_add_f32 v220, v220, v221
    v_lshlrev_b32 v72, 16, v38
    v_and_b32 v73, 0xffff0000, v38
    v_add_f32_dpp v218, v218, v218 quad_perm:[1,0,3,2] row_mask:0xf bank_mask:0xf
    v_add_f32_dpp v220, v220, v220 quad_perm:[1,0,3,2] row_mask:0xf bank_mask:0xf
    v_lshlrev_b32 v74, 16, v39
    v_and_b32 v75, 0xffff0000, v39
    v_add_f32_dpp v218, v218, v218 quad_perm:[2,3,0,1] row_mask:0xf bank_mask:0xf
    v_add_f32_dpp v220, v220, v220 quad_perm:[2,3,0,1] row_mask:0xf bank_mask:0xf
    v_lshlrev_b32 v76, 16, v40
    v_and_b32 v77, 0xffff0000, v40
    v_add_f32_dpp v218, v218, v218 row_half_mirror row_mask:0xf bank_mask:0xf
    v_add_f32_dpp v220, v220, v220 row_half_mirror row_mask:0xf bank_mask:0xf
    v_mul_f32 v218, 0x3b000000, v218
    v_mul_f32 v220, 0x3b000000, v220
    v_fma_f32 v220, -v218, v218, v220
    v_max_f32 v220, 0, v220
    v_mov_b32 v5, 0x3727c5ac
    v_add_f32 v222, v220, v5
    v_rsq_f32 v222, v222
    v_lshlrev_b32 v78, 16, v41
    v_and_b32 v79, 0xffff0000, v41
    v_mul_f32 v224, v222, v222
    v_fma_f32 v224, v224, v220, v5
    v_rsq_f32 v224, v224
    v_mul_f32 v218, v218, v222
    s_mov_b32 s48, s14
    s_mov_b32 s49, s15
    s_mov_b32 s50, 0x560000
    s_mov_b32 s51, 0x20000
    s_bfe_u32 s3, s2, 0x30003
    s_lshl_b32 s65, s28, 3
    s_add_u32 s3, s3, s65
    s_add_u32 s65, s91, 0
    s_and_b32 s65, s65, 7
    s_lshl_b32 s65, s65, 12
    v_add_u32 v236, s65, v214
    v_pk_fma_f32 v[68:69], v[68:69], v[222:223], v[218:219] op_sel_hi:[1,0,0] neg_lo:[0,0,1] neg_hi:[0,0,1]
    v_cvt_pk_bf16_f32 v36, v68, v69
    v_pk_fma_f32 v[70:71], v[70:71], v[222:223], v[218:219] op_sel_hi:[1,0,0] neg_lo:[0,0,1] neg_hi:[0,0,1]
    v_cvt_pk_bf16_f32 v37, v70, v71
    v_pk_fma_f32 v[72:73], v[72:73], v[222:223], v[218:219] op_sel_hi:[1,0,0] neg_lo:[0,0,1] neg_hi:[0,0,1]
    v_cvt_pk_bf16_f32 v38, v72, v73
    v_pk_fma_f32 v[74:75], v[74:75], v[222:223], v[218:219] op_sel_hi:[1,0,0] neg_lo:[0,0,1] neg_hi:[0,0,1]
    v_cvt_pk_bf16_f32 v39, v74, v75
    ds_write_b128 v236, v[36:39]
    ds_read_b64_tr_b16 v[228:229], v215
    ds_read_b64_tr_b16 v[230:231], v216
    v_readlane_b32 s80, v224, 0
    v_readlane_b32 s81, v224, 8
    v_readlane_b32 s82, v224, 16
    v_readlane_b32 s83, v224, 24
    v_readlane_b32 s84, v224, 32
    v_readlane_b32 s85, v224, 40
    v_readlane_b32 s86, v224, 48
    v_readlane_b32 s87, v224, 56
    s_add_u32 s65, s91, 1
    s_and_b32 s65, s65, 7
    s_lshl_b32 s65, s65, 12
    v_add_u32 v237, s65, v214
    v_pk_fma_f32 v[76:77], v[76:77], v[222:223], v[218:219] op_sel_hi:[1,0,0] neg_lo:[0,0,1] neg_hi:[0,0,1]
    v_cvt_pk_bf16_f32 v40, v76, v77
    v_pk_fma_f32 v[78:79], v[78:79], v[222:223], v[218:219] op_sel_hi:[1,0,0] neg_lo:[0,0,1] neg_hi:[0,0,1]
    v_cvt_pk_bf16_f32 v41, v78, v79
    v_lshlrev_b32 v80, 16, v42
    v_and_b32 v81, 0xffff0000, v42
    v_pk_fma_f32 v[80:81], v[80:81], v[222:223], v[218:219] op_sel_hi:[1,0,0] neg_lo:[0,0,1] neg_hi:[0,0,1]
    v_cvt_pk_bf16_f32 v42, v80, v81
    v_lshlrev_b32 v82, 16, v43
    v_and_b32 v83, 0xffff0000, v43
    v_pk_fma_f32 v[82:83], v[82:83], v[222:223], v[218:219] op_sel_hi:[1,0,0] neg_lo:[0,0,1] neg_hi:[0,0,1]
    v_cvt_pk_bf16_f32 v43, v82, v83
    ds_write_b128 v237, v[40:43]
    s_waitcnt lgkmcnt(0)
    v_lshlrev_b32 v6, 16, v228
    v_and_b32 v8, 0xffff0000, v228
    v_mul_f32 v6, s80, v6
    v_mul_f32 v8, s81, v8
    v_cvt_pk_bf16_f32 v232, v6, v8
    v_lshlrev_b32 v6, 16, v229
    v_and_b32 v8, 0xffff0000, v229
    v_mul_f32 v6, s82, v6
    v_mul_f32 v8, s83, v8
    v_cvt_pk_bf16_f32 v233, v6, v8
    v_lshlrev_b32 v6, 16, v230
    v_and_b32 v8, 0xffff0000, v230
    v_mul_f32 v6, s84, v6
    v_mul_f32 v8, s85, v8
    v_cvt_pk_bf16_f32 v234, v6, v8
    v_lshlrev_b32 v6, 16, v231
    v_and_b32 v8, 0xffff0000, v231
    v_mul_f32 v6, s86, v6
    v_mul_f32 v8, s87, v8
    v_cvt_pk_bf16_f32 v235, v6, v8
    buffer_store_dwordx4 v[232:235], v217, s[56:59], 0 offen sc1
    s_add_u32 s65, s91, 2
    s_and_b32 s65, s65, 7
    s_lshl_b32 s65, s65, 12
    v_add_u32 v236, s65, v214
    v_lshlrev_b32 v84, 16, v44
    v_and_b32 v85, 0xffff0000, v44
    v_pk_fma_f32 v[84:85], v[84:85], v[222:223], v[218:219] op_sel_hi:[1,0,0] neg_lo:[0,0,1] neg_hi:[0,0,1]
    v_cvt_pk_bf16_f32 v44, v84, v85
    v_lshlrev_b32 v86, 16, v45
    v_and_b32 v87, 0xffff0000, v45
    v_pk_fma_f32 v[86:87], v[86:87], v[222:223], v[218:219] op_sel_hi:[1,0,0] neg_lo:[0,0,1] neg_hi:[0,0,1]
    v_cvt_pk_bf16_f32 v45, v86, v87
    v_lshlrev_b32 v88, 16, v46
    v_and_b32 v89, 0xffff0000, v46
    v_pk_fma_f32 v[88:89], v[88:89], v[222:223], v[218:219] op_sel_hi:[1,0,0] neg_lo:[0,0,1] neg_hi:[0,0,1]
    v_cvt_pk_bf16_f32 v46, v88, v89
    v_lshlrev_b32 v90, 16, v47
    v_and_b32 v91, 0xffff0000, v47
    v_pk_fma_f32 v[90:91], v[90:91], v[222:223], v[218:219] op_sel_hi:[1,0,0] neg_lo:[0,0,1] neg_hi:[0,0,1]
    v_cvt_pk_bf16_f32 v47, v90, v91
    ds_write_b128 v236, v[44:47]
    s_add_u32 s65, s91, 3
    s_and_b32 s65, s65, 7
    s_lshl_b32 s65, s65, 12
    v_add_u32 v237, s65, v214
    v_lshlrev_b32 v92, 16, v48
    v_and_b32 v93, 0xffff0000, v48
    v_pk_fma_f32 v[92:93], v[92:93], v[222:223], v[218:219] op_sel_hi:[1,0,0] neg_lo:[0,0,1] neg_hi:[0,0,1]
    v_cvt_pk_bf16_f32 v48, v92, v93
    v_lshlrev_b32 v94, 16, v49
    v_and_b32 v95, 0xffff0000, v49
    v_pk_fma_f32 v[94:95], v[94:95], v[222:223], v[218:219] op_sel_hi:[1,0,0] neg_lo:[0,0,1] neg_hi:[0,0,1]
    v_cvt_pk_bf16_f32 v49, v94, v95
    v_lshlrev_b32 v96, 16, v50
    v_and_b32 v97, 0xffff0000, v50
    v_pk_fma_f32 v[96:97], v[96:97], v[222:223], v[218:219] op_sel_hi:[1,0,0] neg_lo:[0,0,1] neg_hi:[0,0,1]
    v_cvt_pk_bf16_f32 v50, v96, v97
    v_lshlrev_b32 v98, 16, v51
    v_and_b32 v99, 0xffff0000, v51
    v_pk_fma_f32 v[98:99], v[98:99], v[222:223], v[218:219] op_sel_hi:[1,0,0] neg_lo:[0,0,1] neg_hi:[0,0,1]
    v_cvt_pk_bf16_f32 v51, v98, v99
    ds_write_b128 v237, v[48:51]
    s_add_u32 s65, s91, 4
    s_and_b32 s65, s65, 7
    s_lshl_b32 s65, s65, 12
    v_add_u32 v236, s65, v214
    v_lshlrev_b32 v100, 16, v52
    v_and_b32 v101, 0xffff0000, v52
    v_pk_fma_f32 v[100:101], v[100:101], v[222:223], v[218:219] op_sel_hi:[1,0,0] neg_lo:[0,0,1] neg_hi:[0,0,1]
    v_cvt_pk_bf16_f32 v52, v100, v101
    v_lshlrev_b32 v102, 16, v53
    v_and_b32 v103, 0xffff0000, v53
    v_pk_fma_f32 v[102:103], v[102:103], v[222:223], v[218:219] op_sel_hi:[1,0,0] neg_lo:[0,0,1] neg_hi:[0,0,1]
    v_cvt_pk_bf16_f32 v53, v102, v103
    v_lshlrev_b32 v104, 16, v54
    v_and_b32 v105, 0xffff0000, v54
    v_pk_fma_f32 v[104:105], v[104:105], v[222:223], v[218:219] op_sel_hi:[1,0,0] neg_lo:[0,0,1] neg_hi:[0,0,1]
    v_cvt_pk_bf16_f32 v54, v104, v105
    v_lshlrev_b32 v106, 16, v55
    v_and_b32 v107, 0xffff0000, v55
    v_pk_fma_f32 v[106:107], v[106:107], v[222:223], v[218:219] op_sel_hi:[1,0,0] neg_lo:[0,0,1] neg_hi:[0,0,1]
    v_cvt_pk_bf16_f32 v55, v106, v107
    ds_write_b128 v236, v[52:55]
    s_add_u32 s65, s91, 5
    s_and_b32 s65, s65, 7
    s_lshl_b32 s65, s65, 12
    v_add_u32 v237, s65, v214
    v_lshlrev_b32 v108, 16, v56
    v_and_b32 v109, 0xffff0000, v56
    v_pk_fma_f32 v[108:109], v[108:109], v[222:223], v[218:219] op_sel_hi:[1,0,0] neg_lo:[0,0,1] neg_hi:[0,0,1]
    v_cvt_pk_bf16_f32 v56, v108, v109
    v_lshlrev_b32 v110, 16, v57
    v_and_b32 v111, 0xffff0000, v57
    v_pk_fma_f32 v[110:111], v[110:111], v[222:223], v[218:219] op_sel_hi:[1,0,0] neg_lo:[0,0,1] neg_hi:[0,0,1]
    v_cvt_pk_bf16_f32 v57, v110, v111
    v_lshlrev_b32 v112, 16, v58
    v_and_b32 v113, 0xffff0000, v58
    v_pk_fma_f32 v[112:113], v[112:113], v[222:223], v[218:219] op_sel_hi:[1,0,0] neg_lo:[0,0,1] neg_hi:[0,0,1]
    v_cvt_pk_bf16_f32 v58, v112, v113
    v_lshlrev_b32 v114, 16, v59
    v_and_b32 v115, 0xffff0000, v59
    v_pk_fma_f32 v[114:115], v[114:115], v[222:223], v[218:219] op_sel_hi:[1,0,0] neg_lo:[0,0,1] neg_hi:[0,0,1]
    v_cvt_pk_bf16_f32 v59, v114, v115
    ds_write_b128 v237, v[56:59]
    s_add_u32 s65, s91, 6
    s_and_b32 s65, s65, 7
    s_lshl_b32 s65, s65, 12
    v_add_u32 v236, s65, v214
    v_lshlrev_b32 v116, 16, v60
    v_and_b32 v117, 0xffff0000, v60
    v_pk_fma_f32 v[116:117], v[116:117], v[222:223], v[218:219] op_sel_hi:[1,0,0] neg_lo:[0,0,1] neg_hi:[0,0,1]
    v_cvt_pk_bf16_f32 v60, v116, v117
    v_lshlrev_b32 v118, 16, v61
    v_and_b32 v119, 0xffff0000, v61
    v_pk_fma_f32 v[118:119], v[118:119], v[222:223], v[218:219] op_sel_hi:[1,0,0] neg_lo:[0,0,1] neg_hi:[0,0,1]
    v_cvt_pk_bf16_f32 v61, v118, v119
    v_lshlrev_b32 v120, 16, v62
    v_and_b32 v121, 0xffff0000, v62
    v_pk_fma_f32 v[120:121], v[120:121], v[222:223], v[218:219] op_sel_hi:[1,0,0] neg_lo:[0,0,1] neg_hi:[0,0,1]
    v_cvt_pk_bf16_f32 v62, v120, v121
    v_lshlrev_b32 v122, 16, v63
    v_and_b32 v123, 0xffff0000, v63
    v_pk_fma_f32 v[122:123], v[122:123], v[222:223], v[218:219] op_sel_hi:[1,0,0] neg_lo:[0,0,1] neg_hi:[0,0,1]
    v_cvt_pk_bf16_f32 v63, v122, v123
    ds_write_b128 v236, v[60:63]
    s_add_u32 s65, s91, 7
    s_and_b32 s65, s65, 7
    s_lshl_b32 s65, s65, 12
    v_add_u32 v237, s65, v214
    v_lshlrev_b32 v124, 16, v64
    v_and_b32 v125, 0xffff0000, v64
    v_pk_fma_f32 v[124:125], v[124:125], v[222:223], v[218:219] op_sel_hi:[1,0,0] neg_lo:[0,0,1] neg_hi:[0,0,1]
    v_cvt_pk_bf16_f32 v64, v124, v125
    v_lshlrev_b32 v126, 16, v65
    v_and_b32 v127, 0xffff0000, v65
    v_pk_fma_f32 v[126:127], v[126:127], v[222:223], v[218:219] op_sel_hi:[1,0,0] neg_lo:[0,0,1] neg_hi:[0,0,1]
    v_cvt_pk_bf16_f32 v65, v126, v127
    v_lshlrev_b32 v128, 16, v66
    v_and_b32 v129, 0xffff0000, v66
    v_pk_fma_f32 v[128:129], v[128:129], v[222:223], v[218:219] op_sel_hi:[1,0,0] neg_lo:[0,0,1] neg_hi:[0,0,1]
    v_cvt_pk_bf16_f32 v66, v128, v129
    v_lshlrev_b32 v130, 16, v67
    v_and_b32 v131, 0xffff0000, v67
    v_pk_fma_f32 v[130:131], v[130:131], v[222:223], v[218:219] op_sel_hi:[1,0,0] neg_lo:[0,0,1] neg_hi:[0,0,1]
    v_cvt_pk_bf16_f32 v67, v130, v131
    ds_write_b128 v237, v[64:67]
    s_cmp_ge_u32 s28, 6
    s_cbranch_scc1 dw_6
    s_add_u32 s64, s72, 1
    s_and_b32 s64, s64, 7
    s_mul_i32 s64, s64, 196608
    s_add_u32 m0, s70, 24576
    s_nop 0
    buffer_load_dwordx4 v185, s[40:43], s64 offen lds
    s_add_u32 m0, s70, 25600
    s_add_u32 s64, s64, 24576
    buffer_load_dwordx4 v185, s[40:43], s64 offen lds
    s_add_u32 m0, s70, 26624
    s_add_u32 s64, s64, 24576
    buffer_load_dwordx4 v185, s[40:43], s64 offen lds
    s_add_u32 m0, s70, 27648
    s_add_u32 s64, s64, 24576
    buffer_load_dwordx4 v185, s[40:43], s64 offen lds
dw_6:
    s_cmp_ge_u32 s28, 6
    s_cbranch_scc1 dw_7
    s_add_u32 s64, s72, 2
    s_and_b32 s64, s64, 7
    s_mul_i32 s64, s64, 196608
    s_add_u32 m0, s70, 49152
    s_nop 0
    buffer_load_dwordx4 v185, s[40:43], s64 offen lds
    s_add_u32 m0, s70, 50176
    s_add_u32 s64, s64, 24576
    buffer_load_dwordx4 v185, s[40:43], s64 offen lds
    s_add_u32 m0, s70, 51200
    s_add_u32 s64, s64, 24576
    buffer_load_dwordx4 v185, s[40:43], s64 offen lds
    s_add_u32 m0, s70, 52224
    s_add_u32 s64, s64, 24576
    buffer_load_dwordx4 v185, s[40:43], s64 offen lds
dw_7:
    s_cmp_ge_u32 s28, 6
    s_cbranch_scc1 dw_8
    s_add_u32 s64, s72, 3
    s_and_b32 s64, s64, 7
    s_mul_i32 s64, s64, 196608
    s_add_u32 m0, s70, 73728
    s_nop 0
    buffer_load_dwordx4 v185, s[40:43], s64 offen lds
    s_add_u32 m0, s70, 74752
    s_add_u32 s64, s64, 24576
    buffer_load_dwordx4 v185, s[40:43], s64 offen lds
    s_add_u32 m0, s70, 75776
    s_add_u32 s64, s64, 24576
    buffer_load_dwordx4 v185, s[40:43], s64 offen lds
    s_add_u32 m0, s70, 76800
    s_add_u32 s64, s64, 24576
    buffer_load_dwordx4 v185, s[40:43], s64 offen lds
dw_8:
    s_cmp_lg_u32 s28, 7
    s_cbranch_scc1 tg_9
    buffer_load_dword v180, v16, s[60:63], 0 offen sc1
tg_9:
    s_cmp_ge_u32 s28, 6
    s_cbranch_scc1 wl_10
    s_waitcnt vmcnt(12) lgkmcnt(0)
    s_branch wl_11
wl_10:
    s_waitcnt vmcnt(0) lgkmcnt(0)
wl_11:
    s_barrier
    s_cmp_lg_u32 s28, 7
    s_cbranch_scc1 nf_12
    s_mov_b32 s79, 400000
nf_13:
    s_waitcnt vmcnt(0)
    v_readfirstlane_b32 s99, v180
    s_cmp_lg_u32 s99, 0
    s_cbranch_scc1 nf_14
    s_sleep 4
    buffer_load_dword v180, v16, s[60:63], 0 offen sc1
    s_sub_u32 s79, s79, 1
    s_cmp_lg_u32 s79, 0
    s_cbranch_scc1 nf_13
    s_waitcnt vmcnt(0)
nf_14:
    s_lshr_b32 s64, s2, 3
    s_lshl_b32 s64, s64, 7
    s_and_b32 s65, s2, 7
    s_lshl_b32 s65, s65, 2
    s_add_u32 s64, s64, s65
    s_add_u32 s64, s64, 12845056
    s_mov_b64 exec, 1
    v_mov_b32 v5, s99
    buffer_store_dword v5, v16, s[56:59], s64 offen sc1
    s_mov_b64 exec, -1
nf_12:
    ds_read_b128 v[68:71], v186 offset:0
    ds_read_b64_tr_b16 v[76:77], v188 offset:0
    ds_read_b64_tr_b16 v[78:79], v188 offset:512
    ds_read_b64_tr_b16 v[80:81], v188 offset:8192
    ds_read_b64_tr_b16 v[82:83], v188 offset:8704
    ds_read_b64_tr_b16 v[84:85], v188 offset:16384
    ds_read_b64_tr_b16 v[86:87], v188 offset:16896
    ds_read_b128 v[72:75], v187 offset:0
    ds_read_b64_tr_b16 v[88:89], v188 offset:2048
    ds_read_b64_tr_b16 v[90:91], v188 offset:2560
    ds_read_b64_tr_b16 v[92:93], v188 offset:10240
    ds_read_b64_tr_b16 v[94:95], v188 offset:10752
    ds_read_b64_tr_b16 v[96:97], v188 offset:18432
    ds_read_b64_tr_b16 v[98:99], v188 offset:18944
    s_waitcnt lgkmcnt(0)
    v_mfma_f32_32x32x16_bf16 v[132:147], v[76:79], v[68:71], 0
    s_cmp_ge_u32 s28, 6
    s_cbranch_scc1 rw_15
    s_waitcnt vmcnt(8)
rw_15:
    s_barrier
    v_mfma_f32_32x32x16_bf16 v[148:163], v[80:83], v[68:71], 0
    ds_read_b128 v[100:103], v186 offset:4096
    ds_read_b64_tr_b16 v[108:109], v188 offset:24576
    ds_read_b64_tr_b16 v[110:111], v188 offset:25088
    ds_read_b64_tr_b16 v[112:113], v188 offset:32768
    ds_read_b64_tr_b16 v[114:115], v188 offset:33280
    ds_read_b64_tr_b16 v[116:117], v188 offset:40960
    ds_read_b64_tr_b16 v[118:119], v188 offset:41472
    v_mfma_f32_32x32x16_bf16 v[164:179], v[68:71], v[84:87], 0
    ds_read_b128 v[104:107], v187 offset:4096
    ds_read_b64_tr_b16 v[120:121], v188 offset:26624
    ds_read_b64_tr_b16 v[122:123], v188 offset:27136
    ds_read_b64_tr_b16 v[124:125], v188 offset:34816
    ds_read_b64_tr_b16 v[126:127], v188 offset:35328
    ds_read_b64_tr_b16 v[128:129], v188 offset:43008
    ds_read_b64_tr_b16 v[130:131], v188 offset:43520
    v_mfma_f32_32x32x16_bf16 v[132:147], v[88:91], v[72:75], v[132:147]
    s_cmp_ge_u32 s28, 6
    s_cbranch_scc1 dw_16
    s_add_u32 s64, s72, 4
    s_and_b32 s64, s64, 7
    s_mul_i32 s64, s64, 196608
    s_add_u32 m0, s70, 0
    s_nop 0
    buffer_load_dwordx4 v185, s[40:43], s64 offen lds
    s_add_u32 m0, s70, 1024
    s_add_u32 s64, s64, 24576
    buffer_load_dwordx4 v185, s[40:43], s64 offen lds
dw_16:
    v_mfma_f32_32x32x16_bf16 v[148:163], v[92:95], v[72:75], v[148:163]
    s_cmp_ge_u32 s28, 6
    s_cbranch_scc1 dw_17
    s_add_u32 m0, s70, 2048
    s_add_u32 s64, s64, 24576
    buffer_load_dwordx4 v185, s[40:43], s64 offen lds
dw_17:
    v_mfma_f32_32x32x16_bf16 v[164:179], v[72:75], v[96:99], v[164:179]
    s_cmp_ge_u32 s28, 6
    s_cbranch_scc1 dw_18
    s_add_u32 m0, s70, 3072
    s_add_u32 s64, s64, 24576
    buffer_load_dwordx4 v185, s[40:43], s64 offen lds
dw_18:
    s_waitcnt lgkmcnt(0)
    v_mfma_f32_32x32x16_bf16 v[132:147], v[108:111], v[100:103], v[132:147]
    s_cmp_ge_u32 s28, 6
    s_cbranch_scc1 rw_19
    s_waitcnt vmcnt(8)
rw_19:
    s_barrier
    v_mfma_f32_32x32x16_bf16 v[148:163], v[112:115], v[100:103], v[148:163]
    ds_read_b128 v[68:71], v186 offset:8192
    ds_read_b64_tr_b16 v[76:77], v189 offset:0
    ds_read_b64_tr_b16 v[78:79], v189 offset:512
    ds_read_b64_tr_b16 v[80:81], v189 offset:8192
    ds_read_b64_tr_b16 v[82:83], v189 offset:8704
    ds_read_b64_tr_b16 v[84:85], v189 offset:16384
    ds_read_b64_tr_b16 v[86:87], v189 offset:16896
    v_mfma_f32_32x32x16_bf16 v[164:179], v[100:103], v[116:119], v[164:179]
    ds_read_b128 v[72:75], v187 offset:8192
    ds_read_b64_tr_b16 v[88:89], v189 offset:2048
    ds_read_b64_tr_b16 v[90:91], v189 offset:2560
    ds_read_b64_tr_b16 v[92:93], v189 offset:10240
    ds_read_b64_tr_b16 v[94:95], v189 offset:10752
    ds_read_b64_tr_b16 v[96:97], v189 offset:18432
    ds_read_b64_tr_b16 v[98:99], v189 offset:18944
    v_mfma_f32_32x32x16_bf16 v[132:147], v[120:123], v[104:107], v[132:147]
    s_cmp_ge_u32 s28, 6
    s_cbranch_scc1 dw_20
    s_add_u32 s64, s72, 5
    s_and_b32 s64, s64, 7
    s_mul_i32 s64, s64, 196608
    s_add_u32 m0, s70, 24576
    s_nop 0
    buffer_load_dwordx4 v185, s[40:43], s64 offen lds
    s_add_u32 m0, s70, 25600
    s_add_u32 s64, s64, 24576
    buffer_load_dwordx4 v185, s[40:43], s64 offen lds
dw_20:
    v_mfma_f32_32x32x16_bf16 v[148:163], v[124:127], v[104:107], v[148:163]
    s_cmp_ge_u32 s28, 6
    s_cbranch_scc1 dw_21
    s_add_u32 m0, s70, 26624
    s_add_u32 s64, s64, 24576
    buffer_load_dwordx4 v185, s[40:43], s64 offen lds
dw_21:
    v_mfma_f32_32x32x16_bf16 v[164:179], v[104:107], v[128:131], v[164:179]
    s_cmp_ge_u32 s28, 6
    s_cbranch_scc1 dw_22
    s_add_u32 m0, s70, 27648
    s_add_u32 s64, s64, 24576
    buffer_load_dwordx4 v185, s[40:43], s64 offen lds
dw_22:
    s_waitcnt lgkmcnt(0)
    v_mfma_f32_32x32x16_bf16 v[132:147], v[76:79], v[68:71], v[132:147]
    s_cmp_ge_u32 s28, 6
    s_cbranch_scc1 rw_23
    s_waitcnt vmcnt(8)
rw_23:
    s_barrier
    v_mfma_f32_32x32x16_bf16 v[148:163], v[80:83], v[68:71], v[148:163]
    ds_read_b128 v[100:103], v186 offset:12288
    ds_read_b64_tr_b16 v[108:109], v189 offset:24576
    ds_read_b64_tr_b16 v[110:111], v189 offset:25088
    ds_read_b64_tr_b16 v[112:113], v189 offset:32768
    ds_read_b64_tr_b16 v[114:115], v189 offset:33280
    ds_read_b64_tr_b16 v[116:117], v189 offset:40960
    ds_read_b64_tr_b16 v[118:119], v189 offset:41472
    v_mfma_f32_32x32x16_bf16 v[164:179], v[68:71], v[84:87], v[164:179]
    ds_read_b128 v[104:107], v187 offset:12288
    ds_read_b64_tr_b16 v[120:121], v189 offset:26624
    ds_read_b64_tr_b16 v[122:123], v189 offset:27136
    ds_read_b64_tr_b16 v[124:125], v189 offset:34816
    ds_read_b64_tr_b16 v[126:127], v189 offset:35328
    ds_read_b64_tr_b16 v[128:129], v189 offset:43008
    ds_read_b64_tr_b16 v[130:131], v189 offset:43520
    v_mfma_f32_32x32x16_bf16 v[132:147], v[88:91], v[72:75], v[132:147]
    s_cmp_ge_u32 s28, 6
    s_cbranch_scc1 dw_24
    s_add_u32 s64, s72, 6
    s_and_b32 s64, s64, 7
    s_mul_i32 s64, s64, 196608
    s_add_u32 m0, s70, 49152
    s_nop 0
    buffer_load_dwordx4 v185, s[40:43], s64 offen lds
    s_add_u32 m0, s70, 50176
    s_add_u32 s64, s64, 24576
    buffer_load_dwordx4 v185, s[40:43], s64 offen lds
dw_24:
    v_mfma_f32_32x32x16_bf16 v[148:163], v[92:95], v[72:75], v[148:163]
    s_cmp_ge_u32 s28, 6
    s_cbranch_scc1 dw_25
    s_add_u32 m0, s70, 51200
    s_add_u32 s64, s64, 24576
    buffer_load_dwordx4 v185, s[40:43], s64 offen lds
dw_25:
    v_mfma_f32_32x32x16_bf16 v[164:179], v[72:75], v[96:99], v[164:179]
    s_cmp_ge_u32 s28, 6
    s_cbranch_scc1 dw_26
    s_add_u32 m0, s70, 52224
    s_add_u32 s64, s64, 24576
    buffer_load_dwordx4 v185, s[40:43], s64 offen lds
dw_26:
    s_waitcnt lgkmcnt(0)
    v_mfma_f32_32x32x16_bf16 v[132:147], v[108:111], v[100:103], v[132:147]
    s_cmp_ge_u32 s28, 6
    s_cbranch_scc1 rw_27
    s_waitcnt vmcnt(8)
rw_27:
    s_barrier
    v_mfma_f32_32x32x16_bf16 v[148:163], v[112:115], v[100:103], v[148:163]
    ds_read_b128 v[68:71], v186 offset:16384
    ds_read_b64_tr_b16 v[76:77], v188 offset:0
    ds_read_b64_tr_b16 v[78:79], v188 offset:512
    ds_read_b64_tr_b16 v[80:81], v188 offset:8192
    ds_read_b64_tr_b16 v[82:83], v188 offset:8704
    ds_read_b64_tr_b16 v[84:85], v188 offset:16384
    ds_read_b64_tr_b16 v[86:87], v188 offset:16896
    v_mfma_f32_32x32x16_bf16 v[164:179], v[100:103], v[116:119], v[164:179]
    ds_read_b128 v[72:75], v187 offset:16384
    ds_read_b64_tr_b16 v[88:89], v188 offset:2048
    ds_read_b64_tr_b16 v[90:91], v188 offset:2560
    ds_read_b64_tr_b16 v[92:93], v188 offset:10240
    ds_read_b64_tr_b16 v[94:95], v188 offset:10752
    ds_read_b64_tr_b16 v[96:97], v188 offset:18432
    ds_read_b64_tr_b16 v[98:99], v188 offset:18944
    v_mfma_f32_32x32x16_bf16 v[132:147], v[120:123], v[104:107], v[132:147]
    s_cmp_ge_u32 s28, 6
    s_cbranch_scc1 dw_28
    s_add_u32 s64, s72, 7
    s_and_b32 s64, s64, 7
    s_mul_i32 s64, s64, 196608
    s_add_u32 m0, s70, 73728
    s_nop 0
    buffer_load_dwordx4 v185, s[40:43], s64 offen lds
    s_add_u32 m0, s70, 74752
    s_add_u32 s64, s64, 24576
    buffer_load_dwordx4 v185, s[40:43], s64 offen lds
dw_28:
    v_mfma_f32_32x32x16_bf16 v[148:163], v[124:127], v[104:107], v[148:163]
    s_cmp_ge_u32 s28, 6
    s_cbranch_scc1 dw_29
    s_add_u32 m0, s70, 75776
    s_add_u32 s64, s64, 24576
    buffer_load_dwordx4 v185, s[40:43], s64 offen lds
dw_29:
    v_mfma_f32_32x32x16_bf16 v[164:179], v[104:107], v[128:131], v[164:179]
    s_cmp_ge_u32 s28, 6
    s_cbranch_scc1 dw_30
    s_add_u32 m0, s70, 76800
    s_add_u32 s64, s64, 24576
    buffer_load_dwordx4 v185, s[40:43], s64 offen lds
dw_30:
    s_waitcnt lgkmcnt(0)
    v_mfma_f32_32x32x16_bf16 v[132:147], v[76:79], v[68:71], v[132:147]
    s_cmp_ge_u32 s28, 6
    s_cbranch_scc1 rw_31
    s_waitcnt vmcnt(8)
rw_31:
    s_barrier
    v_mfma_f32_32x32x16_bf16 v[148:163], v[80:83], v[68:71], v[148:163]
    ds_read_b128 v[100:103], v186 offset:20480
    ds_read_b64_tr_b16 v[108:109], v188 offset:24576
    ds_read_b64_tr_b16 v[110:111], v188 offset:25088
    ds_read_b64_tr_b16 v[112:113], v188 offset:32768
    ds_read_b64_tr_b16 v[114:115], v188 offset:33280
    ds_read_b64_tr_b16 v[116:117], v188 offset:40960
    ds_read_b64_tr_b16 v[118:119], v188 offset:41472
    v_mfma_f32_32x32x16_bf16 v[164:179], v[68:71], v[84:87], v[164:179]
    ds_read_b128 v[104:107], v187 offset:20480
    ds_read_b64_tr_b16 v[120:121], v188 offset:26624
    ds_read_b64_tr_b16 v[122:123], v188 offset:27136
    ds_read_b64_tr_b16 v[124:125], v188 offset:34816
    ds_read_b64_tr_b16 v[126:127], v188 offset:35328
    ds_read_b64_tr_b16 v[128:129], v188 offset:43008
    ds_read_b64_tr_b16 v[130:131], v188 offset:43520
    v_mfma_f32_32x32x16_bf16 v[132:147], v[88:91], v[72:75], v[132:147]
    v_mfma_f32_32x32x16_bf16 v[148:163], v[92:95], v[72:75], v[148:163]
    v_mfma_f32_32x32x16_bf16 v[164:179], v[72:75], v[96:99], v[164:179]
    s_cmp_lg_u32 s90, 2
    s_cbranch_scc1 rs_32
    buffer_load_ushort v26, v190, s[44:47], 0 offen offset:0
    buffer_load_ushort v27, v190, s[44:47], 0 offen offset:32
    buffer_load_ushort v28, v190, s[44:47], 0 offen offset:64
    buffer_load_ushort v29, v190, s[44:47], 0 offen offset:96
    buffer_load_ushort v30, v190, s[44:47], 0 offen offset:256
    buffer_load_ushort v31, v190, s[44:47], 0 offen offset:288
    buffer_load_ushort v32, v190, s[44:47], 0 offen offset:320
    buffer_load_ushort v33, v190, s[44:47], 0 offen offset:352
rs_32:
    s_waitcnt lgkmcnt(0)
    v_mfma_f32_32x32x16_bf16 v[132:147], v[108:111], v[100:103], v[132:147]
    s_cmp_ge_u32 s28, 6
    s_cbranch_scc1 rw_33
    s_cmp_eq_u32 s90, 1
    s_cbranch_scc1 rw_34
    s_cmp_eq_u32 s90, 2
    s_cbranch_scc1 rw_35
    s_waitcnt vmcnt(4)
    s_branch rw_33
rw_34:
    s_waitcnt vmcnt(4)
    s_branch rw_33
rw_35:
    s_waitcnt vmcnt(12)
rw_33:
    s_barrier
    v_mfma_f32_32x32x16_bf16 v[148:163], v[112:115], v[100:103], v[148:163]
    ds_read_b128 v[68:71], v186 offset:24576
    ds_read_b64_tr_b16 v[76:77], v189 offset:0
    ds_read_b64_tr_b16 v[78:79], v189 offset:512
    ds_read_b64_tr_b16 v[80:81], v189 offset:8192
    ds_read_b64_tr_b16 v[82:83], v189 offset:8704
    ds_read_b64_tr_b16 v[84:85], v189 offset:16384
    ds_read_b64_tr_b16 v[86:87], v189 offset:16896
    v_mfma_f32_32x32x16_bf16 v[164:179], v[100:103], v[116:119], v[164:179]
    ds_read_b128 v[72:75], v187 offset:24576
    ds_read_b64_tr_b16 v[88:89], v189 offset:2048
    ds_read_b64_tr_b16 v[90:91], v189 offset:2560
    ds_read_b64_tr_b16 v[92:93], v189 offset:10240
    ds_read_b64_tr_b16 v[94:95], v189 offset:10752
    ds_read_b64_tr_b16 v[96:97], v189 offset:18432
    ds_read_b64_tr_b16 v[98:99], v189 offset:18944
    v_mfma_f32_32x32x16_bf16 v[132:147], v[120:123], v[104:107], v[132:147]
    v_mfma_f32_32x32x16_bf16 v[148:163], v[124:127], v[104:107], v[148:163]
    v_mfma_f32_32x32x16_bf16 v[164:179], v[104:107], v[128:131], v[164:179]
    s_cmp_lg_u32 s90, 1
    s_cbranch_scc1 rs_36
    s_add_u32 s64, s73, 0
    s_and_b32 s64, s64, 15
    s_add_u32 s64, s64, s88
    s_mul_i32 s64, s64, 88064
    s_add_u32 s65, s64, 44032
    s_add_u32 m0, s89, 0
    s_nop 0
    buffer_load_dwordx4 v20, s[48:51], s64 offen lds
    s_add_u32 m0, s89, 1024
    s_nop 0
    buffer_load_dwordx4 v21, s[48:51], s64 offen lds
    s_add_u32 m0, s89, 2048
    s_nop 0
    buffer_load_dwordx4 v20, s[48:51], s65 offen lds
    s_add_u32 m0, s89, 3072
    s_nop 0
    buffer_load_dwordx4 v21, s[48:51], s65 offen lds
rs_36:
    s_waitcnt lgkmcnt(0)
    v_mfma_f32_32x32x16_bf16 v[132:147], v[76:79], v[68:71], v[132:147]
    s_cmp_ge_u32 s28, 6
    s_cbranch_scc1 rw_37
    s_cmp_eq_u32 s90, 1
    s_cbranch_scc1 rw_38
    s_cmp_eq_u32 s90, 2
    s_cbranch_scc1 rw_39
    s_waitcnt vmcnt(0)
    s_branch rw_37
rw_38:
    s_waitcnt vmcnt(4)
    s_branch rw_37
rw_39:
    s_waitcnt vmcnt(8)
rw_37:
    s_barrier
    v_mfma_f32_32x32x16_bf16 v[148:163], v[80:83], v[68:71], v[148:163]
    ds_read_b128 v[100:103], v186 offset:28672
    ds_read_b64_tr_b16 v[108:109], v189 offset:24576
    ds_read_b64_tr_b16 v[110:111], v189 offset:25088
    ds_read_b64_tr_b16 v[112:113], v189 offset:32768
    ds_read_b64_tr_b16 v[114:115], v189 offset:33280
    ds_read_b64_tr_b16 v[116:117], v189 offset:40960
    ds_read_b64_tr_b16 v[118:119], v189 offset:41472
    v_mfma_f32_32x32x16_bf16 v[164:179], v[68:71], v[84:87], v[164:179]
    ds_read_b128 v[104:107], v187 offset:28672
    ds_read_b64_tr_b16 v[120:121], v189 offset:26624
    ds_read_b64_tr_b16 v[122:123], v189 offset:27136
    ds_read_b64_tr_b16 v[124:125], v189 offset:34816
    ds_read_b64_tr_b16 v[126:127], v189 offset:35328
    ds_read_b64_tr_b16 v[128:129], v189 offset:43008
    ds_read_b64_tr_b16 v[130:131], v189 offset:43520
    v_mfma_f32_32x32x16_bf16 v[132:147], v[88:91], v[72:75], v[132:147]
    v_mfma_f32_32x32x16_bf16 v[148:163], v[92:95], v[72:75], v[148:163]
    v_mfma_f32_32x32x16_bf16 v[164:179], v[72:75], v[96:99], v[164:179]
    s_cmp_lg_u32 s28, 7
    s_cbranch_scc1 rs_40
    buffer_load_dwordx4 v[180:183], v184, s[56:59], s93 offen sc1
rs_40:
    s_cmp_lg_u32 s90, 1
    s_cbranch_scc1 rs_41
    s_add_u32 s64, s73, 1
    s_and_b32 s64, s64, 15
    s_add_u32 s64, s64, s88
    s_mul_i32 s64, s64, 88064
    s_add_u32 s65, s64, 44032
    s_add_u32 m0, s89, 16384
    s_nop 0
    buffer_load_dwordx4 v20, s[48:51], s64 offen lds
    s_add_u32 m0, s89, 17408
    s_nop 0
    buffer_load_dwordx4 v21, s[48:51], s64 offen lds
    s_add_u32 m0, s89, 18432
    s_nop 0
    buffer_load_dwordx4 v20, s[48:51], s65 offen lds
    s_add_u32 m0, s89, 19456
    s_nop 0
    buffer_load_dwordx4 v21, s[48:51], s65 offen lds
rs_41:
    s_waitcnt lgkmcnt(0)
    v_mfma_f32_32x32x16_bf16 v[132:147], v[108:111], v[100:103], v[132:147]
    s_barrier
    v_mfma_f32_32x32x16_bf16 v[148:163], v[112:115], v[100:103], v[148:163]
    v_mfma_f32_32x32x16_bf16 v[164:179], v[100:103], v[116:119], v[164:179]
    v_mfma_f32_32x32x16_bf16 v[132:147], v[120:123], v[104:107], v[132:147]
    v_mfma_f32_32x32x16_bf16 v[148:163], v[124:127], v[104:107], v[148:163]
    v_mfma_f32_32x32x16_bf16 v[164:179], v[104:107], v[128:131], v[164:179]
    s_cmp_lg_u32 s90, 1
    s_cbranch_scc1 rs_42
    s_add_u32 s64, s73, 2
    s_and_b32 s64, s64, 15
    s_add_u32 s64, s64, s88
    s_mul_i32 s64, s64, 88064
    s_add_u32 s65, s64, 44032
    s_add_u32 m0, s89, 32768
    s_nop 0
    buffer_load_dwordx4 v20, s[48:51], s64 offen lds
    s_add_u32 m0, s89, 33792
    s_nop 0
    buffer_load_dwordx4 v21, s[48:51], s64 offen lds
    s_add_u32 m0, s89, 34816
    s_nop 0
    buffer_load_dwordx4 v20, s[48:51], s65 offen lds
    s_add_u32 m0, s89, 35840
    s_nop 0
    buffer_load_dwordx4 v21, s[48:51], s65 offen lds
rs_42:
    s_cmp_eq_u32 s90, 2
    s_cbranch_scc1 L_attn
    s_nop 5
    ds_write_b128 v24, v[132:135] offset:0
    ds_write_b128 v24, v[136:139] offset:1024
    ds_write_b128 v24, v[140:143] offset:2048
    ds_write_b128 v24, v[144:147] offset:3072
    ds_write_b128 v24, v[148:151] offset:4096
    ds_write_b128 v24, v[152:155] offset:5120
    ds_write_b128 v24, v[156:159] offset:6144
    ds_write_b128 v24, v[160:163] offset:7168
    ds_write_b128 v24, v[164:167] offset:8192
    ds_write_b128 v24, v[168:171] offset:9216
    ds_write_b128 v24, v[172:175] offset:10240
    ds_write_b128 v24, v[176:179] offset:11264
    s_mov_b64 exec, 0xff
    v_add_u32 v5, v22, v14
    ds_write_b128 v5, v[16:19]
    s_mov_b64 exec, -1
    s_mov_b32 s40, s16
    s_mov_b32 s41, s17
    s_mov_b32 s42, 0xac0
    s_mov_b32 s43, 0x20000
    s_add_u32 s44, s26, 0x400000
    s_addc_u32 s45, s27, 0
    s_mov_b32 s46, 0x158000
    s_mov_b32 s47, 0x20000
    s_waitcnt lgkmcnt(0)
    s_barrier
    s_cmp_lg_u32 s90, 1
    s_cbranch_scc1 L_nou
    buffer_load_dwordx2 v[228:229], v209, s[40:43], 0 offen
    s_mov_b32 s79, 3200000
lw_43:
    ds_read_b32 v5, v22 offset:20
    s_waitcnt lgkmcnt(0)
    v_readfirstlane_b32 s71, v5
    s_cmp_ge_u32 s71, 1
    s_cbranch_scc1 lwd_44
    s_sleep 1
    s_sub_u32 s79, s79, 1
    s_cmp_lg_u32 s79, 0
    s_cbranch_scc1 lw_43
lwd_44:
    s_mov_b32 s99, s71
    s_add_u32 s64, s73, 0
    s_and_b32 s64, s64, 15
    s_add_u32 s64, s64, s88
    s_lshl_b32 s64, s64, 15
    buffer_load_dwordx4 v[68:71], v200, s[56:59], s64 offen offset:0 sc1
    buffer_load_dwordx4 v[72:75], v200, s[56:59], s64 offen offset:1024 sc1
    buffer_load_dwordx4 v[76:79], v200, s[56:59], s64 offen offset:2048 sc1
    s_add_u32 s64, s73, 1
    s_and_b32 s64, s64, 15
    s_add_u32 s64, s64, s88
    s_lshl_b32 s64, s64, 15
    buffer_load_dwordx4 v[80:83], v200, s[56:59], s64 offen offset:0 sc1
    buffer_load_dwordx4 v[84:87], v200, s[56:59], s64 offen offset:1024 sc1
    buffer_load_dwordx4 v[88:91], v200, s[56:59], s64 offen offset:2048 sc1
    s_add_u32 s64, s89, 98304
    v_add_u32 v230, s64, v14
    s_mul_i32 s64, s77, 3
    s_add_u32 s64, s64, 0
    s_lshr_b32 s65, s64, 2
    s_and_b32 s64, s64, 3
    s_lshl_b32 s65, s65, 14
    s_lshl_b32 s64, s64, 10
    s_add_u32 s64, s64, s65
    s_add_u32 s64, s64, 98304
    v_add_u32 v231, s64, v14
    s_mul_i32 s64, s77, 3
    s_add_u32 s64, s64, 1
    s_lshr_b32 s65, s64, 2
    s_and_b32 s64, s64, 3
    s_lshl_b32 s65, s65, 14
    s_lshl_b32 s64, s64, 10
    s_add_u32 s64, s64, s65
    s_add_u32 s64, s64, 98304
    v_add_u32 v232, s64, v14
    s_mul_i32 s64, s77, 3
    s_add_u32 s64, s64, 2
    s_lshr_b32 s65, s64, 2
    s_and_b32 s64, s64, 3
    s_lshl_b32 s65, s65, 14
    s_lshl_b32 s64, s64, 10
    s_add_u32 s64, s64, s65
    s_add_u32 s64, s64, 98304
    v_add_u32 v233, s64, v14
    v_mov_b32 v234, 0xc0135761
    s_mov_b32 s69, 0xbdd2d3e8
    s_lshl_b32 s68, s31, 2
    s_add_u32 s68, s68, s77
    s_lshl_b32 s68, s68, 14
    s_mul_i32 s64, s32, 48
    v_and_b32 v5, 15, v4
    v_add_u32 v5, s64, v5
    v_and_b32 v6, 1, v11
    v_lshlrev_b32 v6, 9, v6
    v_lshl_add_u32 v6, v10, 3, v6
    v_add_u32 v8, 0, v5
    v_lshrrev_b32 v9, 5, v8
    v_cmp_gt_u32 vcc, 512, v8
    v_and_b32 v8, 31, v8
    v_lshl_add_u32 v8, v8, 4, v6
    v_lshl_add_u32 v8, v9, 10, v8
    v_mov_b32 v9, 0x7fffffff
    v_cndmask_b32 v240, v9, v8, vcc
    v_add_u32 v8, 16, v5
    v_lshrrev_b32 v9, 5, v8
    v_cmp_gt_u32 vcc, 512, v8
    v_and_b32 v8, 31, v8
    v_lshl_add_u32 v8, v8, 4, v6
    v_lshl_add_u32 v8, v9, 10, v8
    v_mov_b32 v9, 0x7fffffff
    v_cndmask_b32 v241, v9, v8, vcc
    v_add_u32 v8, 32, v5
    v_lshrrev_b32 v9, 5, v8
    v_cmp_gt_u32 vcc, 512, v8
    v_and_b32 v8, 31, v8
    v_lshl_add_u32 v8, v8, 4, v6
    v_lshl_add_u32 v8, v9, 10, v8
    v_mov_b32 v9, 0x7fffffff
    v_cndmask_b32 v242, v9, v8, vcc
    s_waitcnt vmcnt(15)
    ds_read_b64_tr_b16 v[36:37], v201 offset:0
    ds_read_b64_tr_b16 v[38:39], v201 offset:512
    ds_read_b64_tr_b16 v[40:41], v202 offset:0
    ds_read_b64_tr_b16 v[42:43], v202 offset:512
    ds_read_b64_tr_b16 v[44:45], v203 offset:0
    ds_read_b64_tr_b16 v[46:47], v203 offset:512
    ds_read_b64_tr_b16 v[48:49], v204 offset:0
    ds_read_b64_tr_b16 v[50:51], v204 offset:512
    s_waitcnt lgkmcnt(0)
    s_add_u32 s64, s73, 2
    s_and_b32 s64, s64, 15
    s_add_u32 s64, s64, s88
    s_lshl_b32 s64, s64, 15
    buffer_load_dwordx4 v[92:95], v200, s[56:59], s64 offen offset:0 sc1
    buffer_load_dwordx4 v[96:99], v200, s[56:59], s64 offen offset:1024 sc1
    buffer_load_dwordx4 v[100:103], v200, s[56:59], s64 offen offset:2048 sc1
    s_add_u32 s64, s73, 3
    s_and_b32 s64, s64, 15
    s_add_u32 s64, s64, s88
    s_mul_i32 s64, s64, 88064
    s_add_u32 s65, s64, 44032
    s_add_u32 m0, s89, 49152
    s_nop 0
    buffer_load_dwordx4 v20, s[48:51], s64 offen lds
    s_add_u32 m0, s89, 50176
    s_nop 0
    buffer_load_dwordx4 v21, s[48:51], s64 offen lds
    s_add_u32 m0, s89, 51200
    s_nop 0
    buffer_load_dwordx4 v20, s[48:51], s65 offen lds
    s_add_u32 m0, s89, 52224
    s_nop 0
    buffer_load_dwordx4 v21, s[48:51], s65 offen lds
    s_waitcnt vmcnt(18)
    ds_read_b64_tr_b16 v[52:53], v201 offset:16384
    ds_read_b64_tr_b16 v[54:55], v201 offset:16896
    ds_read_b64_tr_b16 v[56:57], v202 offset:16384
    ds_read_b64_tr_b16 v[58:59], v202 offset:16896
    ds_read_b64_tr_b16 v[60:61], v203 offset:16384
    ds_read_b64_tr_b16 v[62:63], v203 offset:16896
    ds_read_b64_tr_b16 v[64:65], v204 offset:16384
    ds_read_b64_tr_b16 v[66:67], v204 offset:16896
    s_waitcnt vmcnt(10)
    v_mfma_f32_16x16x32_bf16 v[132:135], v[36:39], v[68:71], 0
    v_mfma_f32_16x16x32_bf16 v[136:139], v[36:39], v[72:75], 0
    v_mfma_f32_16x16x32_bf16 v[140:143], v[36:39], v[76:79], 0
    v_mfma_f32_16x16x32_bf16 v[144:147], v[40:43], v[68:71], 0
    v_mfma_f32_16x16x32_bf16 v[148:151], v[40:43], v[72:75], 0
    v_mfma_f32_16x16x32_bf16 v[152:155], v[40:43], v[76:79], 0
    v_mfma_f32_16x16x32_bf16 v[156:159], v[44:47], v[68:71], 0
    v_mfma_f32_16x16x32_bf16 v[160:163], v[44:47], v[72:75], 0
    v_mfma_f32_16x16x32_bf16 v[164:167], v[44:47], v[76:79], 0
    v_mfma_f32_16x16x32_bf16 v[168:171], v[48:51], v[68:71], 0
    v_mfma_f32_16x16x32_bf16 v[172:175], v[48:51], v[72:75], 0
    v_mfma_f32_16x16x32_bf16 v[176:179], v[48:51], v[76:79], 0
    s_waitcnt lgkmcnt(0)
    s_add_u32 s64, s73, 3
    s_and_b32 s64, s64, 15
    s_add_u32 s64, s64, s88
    s_lshl_b32 s64, s64, 15
    buffer_load_dwordx4 v[68:71], v200, s[56:59], s64 offen offset:0 sc1
    buffer_load_dwordx4 v[72:75], v200, s[56:59], s64 offen offset:1024 sc1
    buffer_load_dwordx4 v[76:79], v200, s[56:59], s64 offen offset:2048 sc1
    s_add_u32 s64, s73, 4
    s_and_b32 s64, s64, 15
    s_add_u32 s64, s64, s88
    s_mul_i32 s64, s64, 88064
    s_add_u32 s65, s64, 44032
    s_add_u32 m0, s89, 65536
    s_nop 0
    buffer_load_dwordx4 v20, s[48:51], s64 offen lds
    s_add_u32 m0, s89, 66560
    s_nop 0
    buffer_load_dwordx4 v21, s[48:51], s64 offen lds
    s_add_u32 m0, s89, 67584
    s_nop 0
    buffer_load_dwordx4 v20, s[48:51], s65 offen lds
    s_add_u32 m0, s89, 68608
    s_nop 0
    buffer_load_dwordx4 v21, s[48:51], s65 offen lds
    ds_read_b64_tr_b16 v[36:37], v201 offset:32768
    ds_read_b64_tr_b16 v[38:39], v201 offset:33280
    ds_read_b64_tr_b16 v[40:41], v202 offset:32768
    ds_read_b64_tr_b16 v[42:43], v202 offset:33280
    ds_read_b64_tr_b16 v[44:45], v203 offset:32768
    ds_read_b64_tr_b16 v[46:47], v203 offset:33280
    ds_read_b64_tr_b16 v[48:49], v204 offset:32768
    ds_read_b64_tr_b16 v[50:51], v204 offset:33280
    s_waitcnt vmcnt(14)
    v_mfma_f32_16x16x32_bf16 v[132:135], v[52:55], v[80:83], v[132:135]
    v_mfma_f32_16x16x32_bf16 v[136:139], v[52:55], v[84:87], v[136:139]
    v_mfma_f32_16x16x32_bf16 v[140:143], v[52:55], v[88:91], v[140:143]
    v_mfma_f32_16x16x32_bf16 v[144:147], v[56:59], v[80:83], v[144:147]
    v_mfma_f32_16x16x32_bf16 v[148:151], v[56:59], v[84:87], v[148:151]
    v_mfma_f32_16x16x32_bf16 v[152:155], v[56:59], v[88:91], v[152:155]
    v_mfma_f32_16x16x32_bf16 v[156:159], v[60:63], v[80:83], v[156:159]
    v_mfma_f32_16x16x32_bf16 v[160:163], v[60:63], v[84:87], v[160:163]
    v_mfma_f32_16x16x32_bf16 v[164:167], v[60:63], v[88:91], v[164:167]
    v_mfma_f32_16x16x32_bf16 v[168:171], v[64:67], v[80:83], v[168:171]
    v_mfma_f32_16x16x32_bf16 v[172:175], v[64:67], v[84:87], v[172:175]
    v_mfma_f32_16x16x32_bf16 v[176:179], v[64:67], v[88:91], v[176:179]
    s_waitcnt lgkmcnt(0)
    s_add_u32 s64, s73, 4
    s_and_b32 s64, s64, 15
    s_add_u32 s64, s64, s88
    s_lshl_b32 s64, s64, 15
    buffer_load_dwordx4 v[80:83], v200, s[56:59], s64 offen offset:0 sc1
    buffer_load_dwordx4 v[84:87], v200, s[56:59], s64 offen offset:1024 sc1
    buffer_load_dwordx4 v[88:91], v200, s[56:59], s64 offen offset:2048 sc1
    s_add_u32 s64, s73, 5
    s_and_b32 s64, s64, 15
    s_add_u32 s64, s64, s88
    s_mul_i32 s64, s64, 88064
    s_add_u32 s65, s64, 44032
    s_add_u32 m0, s89, 0
    s_nop 0
    buffer_load_dwordx4 v20, s[48:51], s64 offen lds
    s_add_u32 m0, s89, 1024
    s_nop 0
    buffer_load_dwordx4 v21, s[48:51], s64 offen lds
    s_add_u32 m0, s89, 2048
    s_nop 0
    buffer_load_dwordx4 v20, s[48:51], s65 offen lds
    s_add_u32 m0, s89, 3072
    s_nop 0
    buffer_load_dwordx4 v21, s[48:51], s65 offen lds
    s_waitcnt vmcnt(14)
    ds_read_b64_tr_b16 v[52:53], v201 offset:49152
    ds_read_b64_tr_b16 v[54:55], v201 offset:49664
    ds_read_b64_tr_b16 v[56:57], v202 offset:49152
    ds_read_b64_tr_b16 v[58:59], v202 offset:49664
    ds_read_b64_tr_b16 v[60:61], v203 offset:49152
    ds_read_b64_tr_b16 v[62:63], v203 offset:49664
    ds_read_b64_tr_b16 v[64:65], v204 offset:49152
    ds_read_b64_tr_b16 v[66:67], v204 offset:49664
    v_mfma_f32_16x16x32_bf16 v[132:135], v[36:39], v[92:95], v[132:135]
    v_mfma_f32_16x16x32_bf16 v[136:139], v[36:39], v[96:99], v[136:139]
    v_mfma_f32_16x16x32_bf16 v[140:143], v[36:39], v[100:103], v[140:143]
    v_mfma_f32_16x16x32_bf16 v[144:147], v[40:43], v[92:95], v[144:147]
    v_mfma_f32_16x16x32_bf16 v[148:151], v[40:43], v[96:99], v[148:151]
    v_mfma_f32_16x16x32_bf16 v[152:155], v[40:43], v[100:103], v[152:155]
    v_mfma_f32_16x16x32_bf16 v[156:159], v[44:47], v[92:95], v[156:159]
    v_mfma_f32_16x16x32_bf16 v[160:163], v[44:47], v[96:99], v[160:163]
    v_mfma_f32_16x16x32_bf16 v[164:167], v[44:47], v[100:103], v[164:167]
    v_mfma_f32_16x16x32_bf16 v[168:171], v[48:51], v[92:95], v[168:171]
    v_mfma_f32_16x16x32_bf16 v[172:175], v[48:51], v[96:99], v[172:175]
    v_mfma_f32_16x16x32_bf16 v[176:179], v[48:51], v[100:103], v[176:179]
    s_waitcnt lgkmcnt(0)
    s_add_u32 s64, s73, 5
    s_and_b32 s64, s64, 15
    s_add_u32 s64, s64, s88
    s_lshl_b32 s64, s64, 15
    buffer_load_dwordx4 v[92:95], v200, s[56:59], s64 offen offset:0 sc1
    buffer_load_dwordx4 v[96:99], v200, s[56:59], s64 offen offset:1024 sc1
    buffer_load_dwordx4 v[100:103], v200, s[56:59], s64 offen offset:2048 sc1
    s_add_u32 s64, s73, 6
    s_and_b32 s64, s64, 15
    s_add_u32 s64, s64, s88
    s_mul_i32 s64, s64, 88064
    s_add_u32 s65, s64, 44032
    s_add_u32 m0, s89, 16384
    s_nop 0
    buffer_load_dwordx4 v20, s[48:51], s64 offen lds
    s_add_u32 m0, s89, 17408
    s_nop 0
    buffer_load_dwordx4 v21, s[48:51], s64 offen lds
    s_add_u32 m0, s89, 18432
    s_nop 0
    buffer_load_dwordx4 v20, s[48:51], s65 offen lds
    s_add_u32 m0, s89, 19456
    s_nop 0
    buffer_load_dwordx4 v21, s[48:51], s65 offen lds
    s_cmp_lg_u32 s3, 8
    s_cbranch_scc1 pf_45
    v_lshrrev_b32 v5, 3, v4
    v_lshlrev_b32 v5, 12, v5
    v_and_b32 v6, 7, v4
    v_lshl_add_u32 v5, v6, 7, v5
    s_lshr_b32 s64, s2, 3
    s_mul_i32 s64, s64, 43
    s_lshr_b32 s64, s64, 1
    s_and_b32 s65, s2, 1
    s_mul_i32 s65, s65, 688
    s_add_u32 s64, s64, s65
    s_lshl_b32 s64, s64, 12
    s_bfe_u32 s65, s2, 0x20001
    s_lshl_b32 s65, s65, 10
    s_add_u32 s64, s64, s65
    buffer_load_dword v180, v5, s[36:39], s64 offen
    s_add_u32 s64, s64, 32768
    buffer_load_dword v181, v5, s[36:39], s64 offen
    s_add_u32 s64, s64, 32768
    buffer_load_dword v182, v5, s[36:39], s64 offen
    s_add_u32 s64, s64, 32768
    v_lshlrev_b32 v5, 7, v4
    s_lshl_b32 s64, s2, 11
    s_mov_b64 exec, 0xffff
    buffer_load_dword v183, v5, s[52:55], s64 offen
    s_mov_b64 exec, -1
pf_45:
    s_waitcnt vmcnt(14)
    ds_read_b64_tr_b16 v[36:37], v205 offset:0
    ds_read_b64_tr_b16 v[38:39], v205 offset:512
    ds_read_b64_tr_b16 v[40:41], v206 offset:0
    ds_read_b64_tr_b16 v[42:43], v206 offset:512
    ds_read_b64_tr_b16 v[44:45], v207 offset:0
    ds_read_b64_tr_b16 v[46:47], v207 offset:512
    ds_read_b64_tr_b16 v[48:49], v208 offset:0
    ds_read_b64_tr_b16 v[50:51], v208 offset:512
    v_mfma_f32_16x16x32_bf16 v[132:135], v[52:55], v[68:71], v[132:135]
    v_mfma_f32_16x16x32_bf16 v[136:139], v[52:55], v[72:75], v[136:139]
    v_mfma_f32_16x16x32_bf16 v[140:143], v[52:55], v[76:79], v[140:143]
    v_mfma_f32_16x16x32_bf16 v[144:147], v[56:59], v[68:71], v[144:147]
    v_mfma_f32_16x16x32_bf16 v[148:151], v[56:59], v[72:75], v[148:151]
    v_mfma_f32_16x16x32_bf16 v[152:155], v[56:59], v[76:79], v[152:155]
    v_mfma_f32_16x16x32_bf16 v[156:159], v[60:63], v[68:71], v[156:159]
    v_mfma_f32_16x16x32_bf16 v[160:163], v[60:63], v[72:75], v[160:163]
    v_mfma_f32_16x16x32_bf16 v[164:167], v[60:63], v[76:79], v[164:167]
    v_mfma_f32_16x16x32_bf16 v[168:171], v[64:67], v[68:71], v[168:171]
    v_mfma_f32_16x16x32_bf16 v[172:175], v[64:67], v[72:75], v[172:175]
    v_mfma_f32_16x16x32_bf16 v[176:179], v[64:67], v[76:79], v[176:179]
    s_waitcnt lgkmcnt(0)
    s_add_u32 s64, s73, 6
    s_and_b32 s64, s64, 15
    s_add_u32 s64, s64, s88
    s_lshl_b32 s64, s64, 15
    buffer_load_dwordx4 v[68:71], v200, s[56:59], s64 offen offset:0 sc1
    buffer_load_dwordx4 v[72:75], v200, s[56:59], s64 offen offset:1024 sc1
    buffer_load_dwordx4 v[76:79], v200, s[56:59], s64 offen offset:2048 sc1
    s_add_u32 s64, s73, 7
    s_and_b32 s64, s64, 15
    s_add_u32 s64, s64, s88
    s_mul_i32 s64, s64, 88064
    s_add_u32 s65, s64, 44032
    s_add_u32 m0, s89, 32768
    s_nop 0
    buffer_load_dwordx4 v20, s[48:51], s64 offen lds
    s_add_u32 m0, s89, 33792
    s_nop 0
    buffer_load_dwordx4 v21, s[48:51], s64 offen lds
    s_add_u32 m0, s89, 34816
    s_nop 0
    buffer_load_dwordx4 v20, s[48:51], s65 offen lds
    s_add_u32 m0, s89, 35840
    s_nop 0
    buffer_load_dwordx4 v21, s[48:51], s65 offen lds
    s_cmp_lg_u32 s3, 9
    s_cbranch_scc1 pf_46
    v_lshrrev_b32 v5, 3, v4
    v_lshlrev_b32 v5, 12, v5
    v_and_b32 v6, 7, v4
    v_lshl_add_u32 v5, v6, 7, v5
    s_lshr_b32 s64, s2, 3
    s_mul_i32 s64, s64, 43
    s_lshr_b32 s64, s64, 1
    s_and_b32 s65, s2, 1
    s_mul_i32 s65, s65, 688
    s_add_u32 s64, s64, s65
    s_lshl_b32 s64, s64, 12
    s_bfe_u32 s65, s2, 0x20001
    s_lshl_b32 s65, s65, 10
    s_add_u32 s64, s64, s65
    buffer_load_dword v180, v5, s[36:39], s64 offen
    s_add_u32 s64, s64, 32768
    buffer_load_dword v181, v5, s[36:39], s64 offen
    s_add_u32 s64, s64, 32768
    buffer_load_dword v182, v5, s[36:39], s64 offen
    s_add_u32 s64, s64, 32768
    v_lshlrev_b32 v5, 7, v4
    s_lshl_b32 s64, s2, 11
    s_mov_b64 exec, 0xffff
    buffer_load_dword v183, v5, s[52:55], s64 offen
    s_mov_b64 exec, -1
pf_46:
    s_waitcnt vmcnt(14)
    ds_read_b64_tr_b16 v[52:53], v201 offset:0
    ds_read_b64_tr_b16 v[54:55], v201 offset:512
    ds_read_b64_tr_b16 v[56:57], v202 offset:0
    ds_read_b64_tr_b16 v[58:59], v202 offset:512
    ds_read_b64_tr_b16 v[60:61], v203 offset:0
    ds_read_b64_tr_b16 v[62:63], v203 offset:512
    ds_read_b64_tr_b16 v[64:65], v204 offset:0
    ds_read_b64_tr_b16 v[66:67], v204 offset:512
    v_mfma_f32_16x16x32_bf16 v[132:135], v[36:39], v[80:83], v[132:135]
    v_mfma_f32_16x16x32_bf16 v[136:139], v[36:39], v[84:87], v[136:139]
    v_mfma_f32_16x16x32_bf16 v[140:143], v[36:39], v[88:91], v[140:143]
    v_mfma_f32_16x16x32_bf16 v[144:147], v[40:43], v[80:83], v[144:147]
    v_mfma_f32_16x16x32_bf16 v[148:151], v[40:43], v[84:87], v[148:151]
    v_mfma_f32_16x16x32_bf16 v[152:155], v[40:43], v[88:91], v[152:155]
    v_mfma_f32_16x16x32_bf16 v[156:159], v[44:47], v[80:83], v[156:159]
    v_mfma_f32_16x16x32_bf16 v[160:163], v[44:47], v[84:87], v[160:163]
    v_mfma_f32_16x16x32_bf16 v[164:167], v[44:47], v[88:91], v[164:167]
    v_mfma_f32_16x16x32_bf16 v[168:171], v[48:51], v[80:83], v[168:171]
    v_mfma_f32_16x16x32_bf16 v[172:175], v[48:51], v[84:87], v[172:175]
    v_mfma_f32_16x16x32_bf16 v[176:179], v[48:51], v[88:91], v[176:179]
    s_waitcnt lgkmcnt(0)
    s_add_u32 s64, s73, 7
    s_and_b32 s64, s64, 15
    s_add_u32 s64, s64, s88
    s_lshl_b32 s64, s64, 15
    buffer_load_dwordx4 v[80:83], v200, s[56:59], s64 offen offset:0 sc1
    buffer_load_dwordx4 v[84:87], v200, s[56:59], s64 offen offset:1024 sc1
    buffer_load_dwordx4 v[88:91], v200, s[56:59], s64 offen offset:2048 sc1
    s_add_u32 s64, s73, 8
    s_and_b32 s64, s64, 15
    s_add_u32 s64, s64, s88
    s_mul_i32 s64, s64, 88064
    s_add_u32 s65, s64, 44032
    s_add_u32 m0, s89, 49152
    s_nop 0
    buffer_load_dwordx4 v20, s[48:51], s64 offen lds
    s_add_u32 m0, s89, 50176
    s_nop 0
    buffer_load_dwordx4 v21, s[48:51], s64 offen lds
    s_add_u32 m0, s89, 51200
    s_nop 0
    buffer_load_dwordx4 v20, s[48:51], s65 offen lds
    s_add_u32 m0, s89, 52224
    s_nop 0
    buffer_load_dwordx4 v21, s[48:51], s65 offen lds
    s_cmp_lg_u32 s3, 10
    s_cbranch_scc1 pf_47
    v_lshrrev_b32 v5, 3, v4
    v_lshlrev_b32 v5, 12, v5
    v_and_b32 v6, 7, v4
    v_lshl_add_u32 v5, v6, 7, v5
    s_lshr_b32 s64, s2, 3
    s_mul_i32 s64, s64, 43
    s_lshr_b32 s64, s64, 1
    s_and_b32 s65, s2, 1
    s_mul_i32 s65, s65, 688
    s_add_u32 s64, s64, s65
    s_lshl_b32 s64, s64, 12
    s_bfe_u32 s65, s2, 0x20001
    s_lshl_b32 s65, s65, 10
    s_add_u32 s64, s64, s65
    buffer_load_dword v180, v5, s[36:39], s64 offen
    s_add_u32 s64, s64, 32768
    buffer_load_dword v181, v5, s[36:39], s64 offen
    s_add_u32 s64, s64, 32768
    buffer_load_dword v182, v5, s[36:39], s64 offen
    s_add_u32 s64, s64, 32768
    v_lshlrev_b32 v5, 7, v4
    s_lshl_b32 s64, s2, 11
    s_mov_b64 exec, 0xffff
    buffer_load_dword v183, v5, s[52:55], s64 offen
    s_mov_b64 exec, -1
pf_47:
    s_waitcnt vmcnt(14)
    ds_read_b64_tr_b16 v[36:37], v201 offset:16384
    ds_read_b64_tr_b16 v[38:39], v201 offset:16896
    ds_read_b64_tr_b16 v[40:41], v202 offset:16384
    ds_read_b64_tr_b16 v[42:43], v202 offset:16896
    ds_read_b64_tr_b16 v[44:45], v203 offset:16384
    ds_read_b64_tr_b16 v[46:47], v203 offset:16896
    ds_read_b64_tr_b16 v[48:49], v204 offset:16384
    ds_read_b64_tr_b16 v[50:51], v204 offset:16896
    v_mfma_f32_16x16x32_bf16 v[132:135], v[52:55], v[92:95], v[132:135]
    v_mfma_f32_16x16x32_bf16 v[136:139], v[52:55], v[96:99], v[136:139]
    v_mfma_f32_16x16x32_bf16 v[140:143], v[52:55], v[100:103], v[140:143]
    v_mfma_f32_16x16x32_bf16 v[144:147], v[56:59], v[92:95], v[144:147]
    v_mfma_f32_16x16x32_bf16 v[148:151], v[56:59], v[96:99], v[148:151]
    v_mfma_f32_16x16x32_bf16 v[152:155], v[56:59], v[100:103], v[152:155]
    v_mfma_f32_16x16x32_bf16 v[156:159], v[60:63], v[92:95], v[156:159]
    v_mfma_f32_16x16x32_bf16 v[160:163], v[60:63], v[96:99], v[160:163]
    v_mfma_f32_16x16x32_bf16 v[164:167], v[60:63], v[100:103], v[164:167]
    v_mfma_f32_16x16x32_bf16 v[168:171], v[64:67], v[92:95], v[168:171]
    v_mfma_f32_16x16x32_bf16 v[172:175], v[64:67], v[96:99], v[172:175]
    v_mfma_f32_16x16x32_bf16 v[176:179], v[64:67], v[100:103], v[176:179]
    s_waitcnt lgkmcnt(0)
    s_add_u32 s64, s73, 8
    s_and_b32 s64, s64, 15
    s_add_u32 s64, s64, s88
    s_lshl_b32 s64, s64, 15
    buffer_load_dwordx4 v[92:95], v200, s[56:59], s64 offen offset:0 sc1
    buffer_load_dwordx4 v[96:99], v200, s[56:59], s64 offen offset:1024 sc1
    buffer_load_dwordx4 v[100:103], v200, s[56:59], s64 offen offset:2048 sc1
    s_add_u32 s64, s73, 9
    s_and_b32 s64, s64, 15
    s_add_u32 s64, s64, s88
    s_mul_i32 s64, s64, 88064
    s_add_u32 s65, s64, 44032
    s_add_u32 m0, s89, 65536
    s_nop 0
    buffer_load_dwordx4 v20, s[48:51], s64 offen lds
    s_add_u32 m0, s89, 66560
    s_nop 0
    buffer_load_dwordx4 v21, s[48:51], s64 offen lds
    s_add_u32 m0, s89, 67584
    s_nop 0
    buffer_load_dwordx4 v20, s[48:51], s65 offen lds
    s_add_u32 m0, s89, 68608
    s_nop 0
    buffer_load_dwordx4 v21, s[48:51], s65 offen lds
    s_cmp_lg_u32 s3, 11
    s_cbranch_scc1 pf_48
    v_lshrrev_b32 v5, 3, v4
    v_lshlrev_b32 v5, 12, v5
    v_and_b32 v6, 7, v4
    v_lshl_add_u32 v5, v6, 7, v5
    s_lshr_b32 s64, s2, 3
    s_mul_i32 s64, s64, 43
    s_lshr_b32 s64, s64, 1
    s_and_b32 s65, s2, 1
    s_mul_i32 s65, s65, 688
    s_add_u32 s64, s64, s65
    s_lshl_b32 s64, s64, 12
    s_bfe_u32 s65, s2, 0x20001
    s_lshl_b32 s65, s65, 10
    s_add_u32 s64, s64, s65
    buffer_load_dword v180, v5, s[36:39], s64 offen
    s_add_u32 s64, s64, 32768
    buffer_load_dword v181, v5, s[36:39], s64 offen
    s_add_u32 s64, s64, 32768
    buffer_load_dword v182, v5, s[36:39], s64 offen
    s_add_u32 s64, s64, 32768
    v_lshlrev_b32 v5, 7, v4
    s_lshl_b32 s64, s2, 11
    s_mov_b64 exec, 0xffff
    buffer_load_dword v183, v5, s[52:55], s64 offen
    s_mov_b64 exec, -1
pf_48:
    s_waitcnt vmcnt(14)
    ds_read_b64_tr_b16 v[52:53], v201 offset:32768
    ds_read_b64_tr_b16 v[54:55], v201 offset:33280
    ds_read_b64_tr_b16 v[56:57], v202 offset:32768
    ds_read_b64_tr_b16 v[58:59], v202 offset:33280
    ds_read_b64_tr_b16 v[60:61], v203 offset:32768
    ds_read_b64_tr_b16 v[62:63], v203 offset:33280
    ds_read_b64_tr_b16 v[64:65], v204 offset:32768
    ds_read_b64_tr_b16 v[66:67], v204 offset:33280
    v_mfma_f32_16x16x32_bf16 v[132:135], v[36:39], v[68:71], v[132:135]
    v_mfma_f32_16x16x32_bf16 v[136:139], v[36:39], v[72:75], v[136:139]
    v_mfma_f32_16x16x32_bf16 v[140:143], v[36:39], v[76:79], v[140:143]
    v_mfma_f32_16x16x32_bf16 v[144:147], v[40:43], v[68:71], v[144:147]
    v_mfma_f32_16x16x32_bf16 v[148:151], v[40:43], v[72:75], v[148:151]
    v_mfma_f32_16x16x32_bf16 v[152:155], v[40:43], v[76:79], v[152:155]
    v_mfma_f32_16x16x32_bf16 v[156:159], v[44:47], v[68:71], v[156:159]
    v_mfma_f32_16x16x32_bf16 v[160:163], v[44:47], v[72:75], v[160:163]
    v_mfma_f32_16x16x32_bf16 v[164:167], v[44:47], v[76:79], v[164:167]
    v_mfma_f32_16x16x32_bf16 v[168:171], v[48:51], v[68:71], v[168:171]
    v_mfma_f32_16x16x32_bf16 v[172:175], v[48:51], v[72:75], v[172:175]
    v_mfma_f32_16x16x32_bf16 v[176:179], v[48:51], v[76:79], v[176:179]
    s_waitcnt lgkmcnt(0)
    s_add_u32 s64, s73, 9
    s_and_b32 s64, s64, 15
    s_add_u32 s64, s64, s88
    s_lshl_b32 s64, s64, 15
    buffer_load_dwordx4 v[68:71], v200, s[56:59], s64 offen offset:0 sc1
    buffer_load_dwordx4 v[72:75], v200, s[56:59], s64 offen offset:1024 sc1
    buffer_load_dwordx4 v[76:79], v200, s[56:59], s64 offen offset:2048 sc1
    s_add_u32 s64, s73, 10
    s_and_b32 s64, s64, 15
    s_add_u32 s64, s64, s88
    s_mul_i32 s64, s64, 88064
    s_add_u32 s65, s64, 44032
    s_add_u32 m0, s89, 0
    s_nop 0
    buffer_load_dwordx4 v20, s[48:51], s64 offen lds
    s_add_u32 m0, s89, 1024
    s_nop 0
    buffer_load_dwordx4 v21, s[48:51], s64 offen lds
    s_add_u32 m0, s89, 2048
    s_nop 0
    buffer_load_dwordx4 v20, s[48:51], s65 offen lds
    s_add_u32 m0, s89, 3072
    s_nop 0
    buffer_load_dwordx4 v21, s[48:51], s65 offen lds
    s_cmp_lg_u32 s3, 12
    s_cbranch_scc1 pf_49
    v_lshrrev_b32 v5, 3, v4
    v_lshlrev_b32 v5, 12, v5
    v_and_b32 v6, 7, v4
    v_lshl_add_u32 v5, v6, 7, v5
    s_lshr_b32 s64, s2, 3
    s_mul_i32 s64, s64, 43
    s_lshr_b32 s64, s64, 1
    s_and_b32 s65, s2, 1
    s_mul_i32 s65, s65, 688
    s_add_u32 s64, s64, s65
    s_lshl_b32 s64, s64, 12
    s_bfe_u32 s65, s2, 0x20001
    s_lshl_b32 s65, s65, 10
    s_add_u32 s64, s64, s65
    buffer_load_dword v180, v5, s[36:39], s64 offen
    s_add_u32 s64, s64, 32768
    buffer_load_dword v181, v5, s[36:39], s64 offen
    s_add_u32 s64, s64, 32768
    buffer_load_dword v182, v5, s[36:39], s64 offen
    s_add_u32 s64, s64, 32768
    v_lshlrev_b32 v5, 7, v4
    s_lshl_b32 s64, s2, 11
    s_mov_b64 exec, 0xffff
    buffer_load_dword v183, v5, s[52:55], s64 offen
    s_mov_b64 exec, -1
pf_49:
    s_waitcnt vmcnt(14)
    ds_read_b64_tr_b16 v[36:37], v201 offset:49152
    ds_read_b64_tr_b16 v[38:39], v201 offset:49664
    ds_read_b64_tr_b16 v[40:41], v202 offset:49152
    ds_read_b64_tr_b16 v[42:43], v202 offset:49664
    ds_read_b64_tr_b16 v[44:45], v203 offset:49152
    ds_read_b64_tr_b16 v[46:47], v203 offset:49664
    ds_read_b64_tr_b16 v[48:49], v204 offset:49152
    ds_read_b64_tr_b16 v[50:51], v204 offset:49664
    v_mfma_f32_16x16x32_bf16 v[132:135], v[52:55], v[80:83], v[132:135]
    v_mfma_f32_16x16x32_bf16 v[136:139], v[52:55], v[84:87], v[136:139]
    v_mfma_f32_16x16x32_bf16 v[140:143], v[52:55], v[88:91], v[140:143]
    v_mfma_f32_16x16x32_bf16 v[144:147], v[56:59], v[80:83], v[144:147]
    v_mfma_f32_16x16x32_bf16 v[148:151], v[56:59], v[84:87], v[148:151]
    v_mfma_f32_16x16x32_bf16 v[152:155], v[56:59], v[88:91], v[152:155]
    v_mfma_f32_16x16x32_bf16 v[156:159], v[60:63], v[80:83], v[156:159]
    v_mfma_f32_16x16x32_bf16 v[160:163], v[60:63], v[84:87], v[160:163]
    v_mfma_f32_16x16x32_bf16 v[164:167], v[60:63], v[88:91], v[164:167]
    v_mfma_f32_16x16x32_bf16 v[168:171], v[64:67], v[80:83], v[168:171]
    v_mfma_f32_16x16x32_bf16 v[172:175], v[64:67], v[84:87], v[172:175]
    v_mfma_f32_16x16x32_bf16 v[176:179], v[64:67], v[88:91], v[176:179]
    s_waitcnt lgkmcnt(0)
    s_add_u32 s64, s73, 10
    s_and_b32 s64, s64, 15
    s_add_u32 s64, s64, s88
    s_lshl_b32 s64, s64, 15
    buffer_load_dwordx4 v[80:83], v200, s[56:59], s64 offen offset:0 sc1
    buffer_load_dwordx4 v[84:87], v200, s[56:59], s64 offen offset:1024 sc1
    buffer_load_dwordx4 v[88:91], v200, s[56:59], s64 offen offset:2048 sc1
    s_add_u32 s64, s73, 11
    s_and_b32 s64, s64, 15
    s_add_u32 s64, s64, s88
    s_mul_i32 s64, s64, 88064
    s_add_u32 s65, s64, 44032
    s_add_u32 m0, s89, 16384
    s_nop 0
    buffer_load_dwordx4 v20, s[48:51], s64 offen lds
    s_add_u32 m0, s89, 17408
    s_nop 0
    buffer_load_dwordx4 v21, s[48:51], s64 offen lds
    s_add_u32 m0, s89, 18432
    s_nop 0
    buffer_load_dwordx4 v20, s[48:51], s65 offen lds
    s_add_u32 m0, s89, 19456
    s_nop 0
    buffer_load_dwordx4 v21, s[48:51], s65 offen lds
    s_waitcnt lgkmcnt(0)
    s_mov_b64 exec, 1
    ds_add_u32 v22, v23 offset:48
    s_mov_b64 exec, -1
    s_cmp_lg_u32 s3, 13
    s_cbranch_scc1 pf_50
    v_lshrrev_b32 v5, 3, v4
    v_lshlrev_b32 v5, 12, v5
    v_and_b32 v6, 7, v4
    v_lshl_add_u32 v5, v6, 7, v5
    s_lshr_b32 s64, s2, 3
    s_mul_i32 s64, s64, 43
    s_lshr_b32 s64, s64, 1
    s_and_b32 s65, s2, 1
    s_mul_i32 s65, s65, 688
    s_add_u32 s64, s64, s65
    s_lshl_b32 s64, s64, 12
    s_bfe_u32 s65, s2, 0x20001
    s_lshl_b32 s65, s65, 10
    s_add_u32 s64, s64, s65
    buffer_load_dword v180, v5, s[36:39], s64 offen
    s_add_u32 s64, s64, 32768
    buffer_load_dword v181, v5, s[36:39], s64 offen
    s_add_u32 s64, s64, 32768
    buffer_load_dword v182, v5, s[36:39], s64 offen
    s_add_u32 s64, s64, 32768
    v_lshlrev_b32 v5, 7, v4
    s_lshl_b32 s64, s2, 11
    s_mov_b64 exec, 0xffff
    buffer_load_dword v183, v5, s[52:55], s64 offen
    s_mov_b64 exec, -1
pf_50:
    s_waitcnt vmcnt(14)
    ds_read_b64_tr_b16 v[52:53], v205 offset:0
    ds_read_b64_tr_b16 v[54:55], v205 offset:512
    ds_read_b64_tr_b16 v[56:57], v206 offset:0
    ds_read_b64_tr_b16 v[58:59], v206 offset:512
    ds_read_b64_tr_b16 v[60:61], v207 offset:0
    ds_read_b64_tr_b16 v[62:63], v207 offset:512
    ds_read_b64_tr_b16 v[64:65], v208 offset:0
    ds_read_b64_tr_b16 v[66:67], v208 offset:512
    v_mfma_f32_16x16x32_bf16 v[132:135], v[36:39], v[92:95], v[132:135]
    v_mfma_f32_16x16x32_bf16 v[136:139], v[36:39], v[96:99], v[136:139]
    v_mfma_f32_16x16x32_bf16 v[140:143], v[36:39], v[100:103], v[140:143]
    v_mfma_f32_16x16x32_bf16 v[144:147], v[40:43], v[92:95], v[144:147]
    v_mfma_f32_16x16x32_bf16 v[148:151], v[40:43], v[96:99], v[148:151]
    v_mfma_f32_16x16x32_bf16 v[152:155], v[40:43], v[100:103], v[152:155]
    v_mfma_f32_16x16x32_bf16 v[156:159], v[44:47], v[92:95], v[156:159]
    v_mfma_f32_16x16x32_bf16 v[160:163], v[44:47], v[96:99], v[160:163]
    v_mfma_f32_16x16x32_bf16 v[164:167], v[44:47], v[100:103], v[164:167]
    v_mfma_f32_16x16x32_bf16 v[168:171], v[48:51], v[92:95], v[168:171]
    v_mfma_f32_16x16x32_bf16 v[172:175], v[48:51], v[96:99], v[172:175]
    v_mfma_f32_16x16x32_bf16 v[176:179], v[48:51], v[100:103], v[176:179]
    s_waitcnt lgkmcnt(0)
    s_add_u32 s64, s73, 11
    s_and_b32 s64, s64, 15
    s_add_u32 s64, s64, s88
    s_lshl_b32 s64, s64, 15
    buffer_load_dwordx4 v[92:95], v200, s[56:59], s64 offen offset:0 sc1
    buffer_load_dwordx4 v[96:99], v200, s[56:59], s64 offen offset:1024 sc1
    buffer_load_dwordx4 v[100:103], v200, s[56:59], s64 offen offset:2048 sc1
    s_add_u32 s64, s73, 12
    s_and_b32 s64, s64, 15
    s_add_u32 s64, s64, s88
    s_mul_i32 s64, s64, 88064
    s_add_u32 s65, s64, 44032
    s_add_u32 m0, s89, 32768
    s_nop 0
    buffer_load_dwordx4 v20, s[48:51], s64 offen lds
    s_add_u32 m0, s89, 33792
    s_nop 0
    buffer_load_dwordx4 v21, s[48:51], s64 offen lds
    s_add_u32 m0, s89, 34816
    s_nop 0
    buffer_load_dwordx4 v20, s[48:51], s65 offen lds
    s_add_u32 m0, s89, 35840
    s_nop 0
    buffer_load_dwordx4 v21, s[48:51], s65 offen lds
    s_cmp_lg_u32 s3, 14
    s_cbranch_scc1 pf_51
    v_lshrrev_b32 v5, 3, v4
    v_lshlrev_b32 v5, 12, v5
    v_and_b32 v6, 7, v4
    v_lshl_add_u32 v5, v6, 7, v5
    s_lshr_b32 s64, s2, 3
    s_mul_i32 s64, s64, 43
    s_lshr_b32 s64, s64, 1
    s_and_b32 s65, s2, 1
    s_mul_i32 s65, s65, 688
    s_add_u32 s64, s64, s65
    s_lshl_b32 s64, s64, 12
    s_bfe_u32 s65, s2, 0x20001
    s_lshl_b32 s65, s65, 10
    s_add_u32 s64, s64, s65
    buffer_load_dword v180, v5, s[36:39], s64 offen
    s_add_u32 s64, s64, 32768
    buffer_load_dword v181, v5, s[36:39], s64 offen
    s_add_u32 s64, s64, 32768
    buffer_load_dword v182, v5, s[36:39], s64 offen
    s_add_u32 s64, s64, 32768
    v_lshlrev_b32 v5, 7, v4
    s_lshl_b32 s64, s2, 11
    s_mov_b64 exec, 0xffff
    buffer_load_dword v183, v5, s[52:55], s64 offen
    s_mov_b64 exec, -1
pf_51:
    s_waitcnt vmcnt(14)
    ds_read_b64_tr_b16 v[36:37], v201 offset:0
    ds_read_b64_tr_b16 v[38:39], v201 offset:512
    ds_read_b64_tr_b16 v[40:41], v202 offset:0
    ds_read_b64_tr_b16 v[42:43], v202 offset:512
    ds_read_b64_tr_b16 v[44:45], v203 offset:0
    ds_read_b64_tr_b16 v[46:47], v203 offset:512
    ds_read_b64_tr_b16 v[48:49], v204 offset:0
    ds_read_b64_tr_b16 v[50:51], v204 offset:512
    v_mfma_f32_16x16x32_bf16 v[132:135], v[52:55], v[68:71], v[132:135]
    v_mfma_f32_16x16x32_bf16 v[136:139], v[52:55], v[72:75], v[136:139]
    v_mfma_f32_16x16x32_bf16 v[140:143], v[52:55], v[76:79], v[140:143]
    v_mfma_f32_16x16x32_bf16 v[144:147], v[56:59], v[68:71], v[144:147]
    v_mfma_f32_16x16x32_bf16 v[148:151], v[56:59], v[72:75], v[148:151]
    v_mfma_f32_16x16x32_bf16 v[152:155], v[56:59], v[76:79], v[152:155]
    v_mfma_f32_16x16x32_bf16 v[156:159], v[60:63], v[68:71], v[156:159]
    v_mfma_f32_16x16x32_bf16 v[160:163], v[60:63], v[72:75], v[160:163]
    v_mfma_f32_16x16x32_bf16 v[164:167], v[60:63], v[76:79], v[164:167]
    v_mfma_f32_16x16x32_bf16 v[168:171], v[64:67], v[68:71], v[168:171]
    v_mfma_f32_16x16x32_bf16 v[172:175], v[64:67], v[72:75], v[172:175]
    v_mfma_f32_16x16x32_bf16 v[176:179], v[64:67], v[76:79], v[176:179]
    s_waitcnt lgkmcnt(0)
    s_add_u32 s64, s73, 12
    s_and_b32 s64, s64, 15
    s_add_u32 s64, s64, s88
    s_lshl_b32 s64, s64, 15
    buffer_load_dwordx4 v[68:71], v200, s[56:59], s64 offen offset:0 sc1
    buffer_load_dwordx4 v[72:75], v200, s[56:59], s64 offen offset:1024 sc1
    buffer_load_dwordx4 v[76:79], v200, s[56:59], s64 offen offset:2048 sc1
    s_add_u32 s64, s73, 13
    s_and_b32 s64, s64, 15
    s_add_u32 s64, s64, s88
    s_mul_i32 s64, s64, 88064
    s_add_u32 s65, s64, 44032
    s_add_u32 m0, s89, 49152
    s_nop 0
    buffer_load_dwordx4 v20, s[48:51], s64 offen lds
    s_add_u32 m0, s89, 50176
    s_nop 0
    buffer_load_dwordx4 v21, s[48:51], s64 offen lds
    s_add_u32 m0, s89, 51200
    s_nop 0
    buffer_load_dwordx4 v20, s[48:51], s65 offen lds
    s_add_u32 m0, s89, 52224
    s_nop 0
    buffer_load_dwordx4 v21, s[48:51], s65 offen lds
    s_mov_b32 s79, 3200000
lw_52:
    ds_read_b32 v5, v22 offset:0
    s_waitcnt lgkmcnt(0)
    v_readfirstlane_b32 s71, v5
    s_cmp_ge_u32 s71, 4
    s_cbranch_scc1 lwd_53
    s_sleep 4
    s_sub_u32 s79, s79, 1
    s_cmp_lg_u32 s79, 0
    s_cbranch_scc1 lw_52
lwd_53:
    s_cmp_lg_u32 s3, 15
    s_cbranch_scc1 pf_54
    v_lshrrev_b32 v5, 3, v4
    v_lshlrev_b32 v5, 12, v5
    v_and_b32 v6, 7, v4
    v_lshl_add_u32 v5, v6, 7, v5
    s_lshr_b32 s64, s2, 3
    s_mul_i32 s64, s64, 43
    s_lshr_b32 s64, s64, 1
    s_and_b32 s65, s2, 1
    s_mul_i32 s65, s65, 688
    s_add_u32 s64, s64, s65
    s_lshl_b32 s64, s64, 12
    s_bfe_u32 s65, s2, 0x20001
    s_lshl_b32 s65, s65, 10
    s_add_u32 s64, s64, s65
    buffer_load_dword v180, v5, s[36:39], s64 offen
    s_add_u32 s64, s64, 32768
    buffer_load_dword v181, v5, s[36:39], s64 offen
    s_add_u32 s64, s64, 32768
    buffer_load_dword v182, v5, s[36:39], s64 offen
    s_add_u32 s64, s64, 32768
    v_lshlrev_b32 v5, 7, v4
    s_lshl_b32 s64, s2, 11
    s_mov_b64 exec, 0xffff
    buffer_load_dword v183, v5, s[52:55], s64 offen
    s_mov_b64 exec, -1
pf_54:
    s_waitcnt vmcnt(14)
    ds_read_b64_tr_b16 v[52:53], v201 offset:16384
    ds_read_b64_tr_b16 v[54:55], v201 offset:16896
    ds_read_b64_tr_b16 v[56:57], v202 offset:16384
    ds_read_b64_tr_b16 v[58:59], v202 offset:16896
    ds_read_b64_tr_b16 v[60:61], v203 offset:16384
    ds_read_b64_tr_b16 v[62:63], v203 offset:16896
    ds_read_b64_tr_b16 v[64:65], v204 offset:16384
    ds_read_b64_tr_b16 v[66:67], v204 offset:16896
    v_mfma_f32_16x16x32_bf16 v[132:135], v[36:39], v[80:83], v[132:135]
    v_mfma_f32_16x16x32_bf16 v[136:139], v[36:39], v[84:87], v[136:139]
    v_mfma_f32_16x16x32_bf16 v[140:143], v[36:39], v[88:91], v[140:143]
    v_mfma_f32_16x16x32_bf16 v[144:147], v[40:43], v[80:83], v[144:147]
    v_mfma_f32_16x16x32_bf16 v[148:151], v[40:43], v[84:87], v[148:151]
    v_mfma_f32_16x16x32_bf16 v[152:155], v[40:43], v[88:91], v[152:155]
    v_mfma_f32_16x16x32_bf16 v[156:159], v[44:47], v[80:83], v[156:159]
    v_mfma_f32_16x16x32_bf16 v[160:163], v[44:47], v[84:87], v[160:163]
    v_mfma_f32_16x16x32_bf16 v[164:167], v[44:47], v[88:91], v[164:167]
    v_mfma_f32_16x16x32_bf16 v[168:171], v[48:51], v[80:83], v[168:171]
    v_mfma_f32_16x16x32_bf16 v[172:175], v[48:51], v[84:87], v[172:175]
    v_mfma_f32_16x16x32_bf16 v[176:179], v[48:51], v[88:91], v[176:179]
    s_waitcnt lgkmcnt(0)
    s_add_u32 s64, s73, 13
    s_and_b32 s64, s64, 15
    s_add_u32 s64, s64, s88
    s_lshl_b32 s64, s64, 15
    buffer_load_dwordx4 v[80:83], v200, s[56:59], s64 offen offset:0 sc1
    buffer_load_dwordx4 v[84:87], v200, s[56:59], s64 offen offset:1024 sc1
    buffer_load_dwordx4 v[88:91], v200, s[56:59], s64 offen offset:2048 sc1
    s_add_u32 s64, s73, 14
    s_and_b32 s64, s64, 15
    s_add_u32 s64, s64, s88
    s_mul_i32 s64, s64, 88064
    s_add_u32 s65, s64, 44032
    s_add_u32 m0, s89, 65536
    s_nop 0
    buffer_load_dwordx4 v20, s[48:51], s64 offen lds
    s_add_u32 m0, s89, 66560
    s_nop 0
    buffer_load_dwordx4 v21, s[48:51], s64 offen lds
    s_add_u32 m0, s89, 67584
    s_nop 0
    buffer_load_dwordx4 v20, s[48:51], s65 offen lds
    s_add_u32 m0, s89, 68608
    s_nop 0
    buffer_load_dwordx4 v21, s[48:51], s65 offen lds
    s_waitcnt vmcnt(14)
    ds_read_b64_tr_b16 v[36:37], v201 offset:32768
    ds_read_b64_tr_b16 v[38:39], v201 offset:33280
    ds_read_b64_tr_b16 v[40:41], v202 offset:32768
    ds_read_b64_tr_b16 v[42:43], v202 offset:33280
    ds_read_b64_tr_b16 v[44:45], v203 offset:32768
    ds_read_b64_tr_b16 v[46:47], v203 offset:33280
    ds_read_b64_tr_b16 v[48:49], v204 offset:32768
    ds_read_b64_tr_b16 v[50:51], v204 offset:33280
    v_mfma_f32_16x16x32_bf16 v[132:135], v[52:55], v[92:95], v[132:135]
    v_mfma_f32_16x16x32_bf16 v[136:139], v[52:55], v[96:99], v[136:139]
    v_mfma_f32_16x16x32_bf16 v[140:143], v[52:55], v[100:103], v[140:143]
    v_mfma_f32_16x16x32_bf16 v[144:147], v[56:59], v[92:95], v[144:147]
    v_mfma_f32_16x16x32_bf16 v[148:151], v[56:59], v[96:99], v[148:151]
    v_mfma_f32_16x16x32_bf16 v[152:155], v[56:59], v[100:103], v[152:155]
    v_mfma_f32_16x16x32_bf16 v[156:159], v[60:63], v[92:95], v[156:159]
    v_mfma_f32_16x16x32_bf16 v[160:163], v[60:63], v[96:99], v[160:163]
    v_mfma_f32_16x16x32_bf16 v[164:167], v[60:63], v[100:103], v[164:167]
    v_mfma_f32_16x16x32_bf16 v[168:171], v[64:67], v[92:95], v[168:171]
    v_mfma_f32_16x16x32_bf16 v[172:175], v[64:67], v[96:99], v[172:175]
    v_mfma_f32_16x16x32_bf16 v[176:179], v[64:67], v[100:103], v[176:179]
    s_waitcnt lgkmcnt(0)
    s_add_u32 s64, s73, 14
    s_and_b32 s64, s64, 15
    s_add_u32 s64, s64, s88
    s_lshl_b32 s64, s64, 15
    buffer_load_dwordx4 v[92:95], v200, s[56:59], s64 offen offset:0 sc1
    buffer_load_dwordx4 v[96:99], v200, s[56:59], s64 offen offset:1024 sc1
    buffer_load_dwordx4 v[100:103], v200, s[56:59], s64 offen offset:2048 sc1
    s_add_u32 s64, s73, 15
    s_and_b32 s64, s64, 15
    s_add_u32 s64, s64, s88
    s_mul_i32 s64, s64, 88064
    s_add_u32 s65, s64, 44032
    s_add_u32 m0, s89, 0
    s_nop 0
    buffer_load_dwordx4 v20, s[48:51], s64 offen lds
    s_add_u32 m0, s89, 1024
    s_nop 0
    buffer_load_dwordx4 v21, s[48:51], s64 offen lds
    s_add_u32 m0, s89, 2048
    s_nop 0
    buffer_load_dwordx4 v20, s[48:51], s65 offen lds
    s_add_u32 m0, s89, 3072
    s_nop 0
    buffer_load_dwordx4 v21, s[48:51], s65 offen lds
    s_waitcnt vmcnt(14)
    ds_read_b64_tr_b16 v[52:53], v201 offset:49152
    ds_read_b64_tr_b16 v[54:55], v201 offset:49664
    ds_read_b64_tr_b16 v[56:57], v202 offset:49152
    ds_read_b64_tr_b16 v[58:59], v202 offset:49664
    ds_read_b64_tr_b16 v[60:61], v203 offset:49152
    ds_read_b64_tr_b16 v[62:63], v203 offset:49664
    ds_read_b64_tr_b16 v[64:65], v204 offset:49152
    ds_read_b64_tr_b16 v[66:67], v204 offset:49664
    v_mfma_f32_16x16x32_bf16 v[132:135], v[36:39], v[68:71], v[132:135]
    v_mfma_f32_16x16x32_bf16 v[136:139], v[36:39], v[72:75], v[136:139]
    v_mfma_f32_16x16x32_bf16 v[140:143], v[36:39], v[76:79], v[140:143]
    v_mfma_f32_16x16x32_bf16 v[144:147], v[40:43], v[68:71], v[144:147]
    v_mfma_f32_16x16x32_bf16 v[148:151], v[40:43], v[72:75], v[148:151]
    v_mfma_f32_16x16x32_bf16 v[152:155], v[40:43], v[76:79], v[152:155]
    v_mfma_f32_16x16x32_bf16 v[156:159], v[44:47], v[68:71], v[156:159]
    v_mfma_f32_16x16x32_bf16 v[160:163], v[44:47], v[72:75], v[160:163]
    v_mfma_f32_16x16x32_bf16 v[164:167], v[44:47], v[76:79], v[164:167]
    v_mfma_f32_16x16x32_bf16 v[168:171], v[48:51], v[68:71], v[168:171]
    v_mfma_f32_16x16x32_bf16 v[172:175], v[48:51], v[72:75], v[172:175]
    v_mfma_f32_16x16x32_bf16 v[176:179], v[48:51], v[76:79], v[176:179]
    s_waitcnt lgkmcnt(0)
    s_add_u32 s64, s73, 15
    s_and_b32 s64, s64, 15
    s_add_u32 s64, s64, s88
    s_lshl_b32 s64, s64, 15
    buffer_load_dwordx4 v[68:71], v200, s[56:59], s64 offen offset:0 sc1
    buffer_load_dwordx4 v[72:75], v200, s[56:59], s64 offen offset:1024 sc1
    buffer_load_dwordx4 v[76:79], v200, s[56:59], s64 offen offset:2048 sc1
    s_add_u32 s64, s75, 0
    s_sub_u32 s71, s64, 11
    s_cmp_ge_u32 s64, 11
    s_cselect_b32 s64, s71, s64
    s_lshl_b32 s64, s64, 2
    s_add_u32 s64, s64, s77
    s_lshl_b32 s64, s64, 17
    s_add_u32 m0, s89, 81920
    s_nop 0
    buffer_load_dwordx4 v193, s[36:39], s64 offen lds
    s_add_u32 m0, s89, 82944
    s_add_u32 s64, s64, 32768
    buffer_load_dwordx4 v193, s[36:39], s64 offen lds
    s_add_u32 m0, s89, 83968
    s_add_u32 s64, s64, 32768
    buffer_load_dwordx4 v193, s[36:39], s64 offen lds
    s_add_u32 m0, s89, 84992
    s_add_u32 s64, s64, 32768
    buffer_load_dwordx4 v193, s[36:39], s64 offen lds
    s_waitcnt vmcnt(14)
    ds_read_b64_tr_b16 v[36:37], v205 offset:0
    ds_read_b64_tr_b16 v[38:39], v205 offset:512
    ds_read_b64_tr_b16 v[40:41], v206 offset:0
    ds_read_b64_tr_b16 v[42:43], v206 offset:512
    ds_read_b64_tr_b16 v[44:45], v207 offset:0
    ds_read_b64_tr_b16 v[46:47], v207 offset:512
    ds_read_b64_tr_b16 v[48:49], v208 offset:0
    ds_read_b64_tr_b16 v[50:51], v208 offset:512
    v_mfma_f32_16x16x32_bf16 v[132:135], v[52:55], v[80:83], v[132:135]
    v_mfma_f32_16x16x32_bf16 v[136:139], v[52:55], v[84:87], v[136:139]
    v_mfma_f32_16x16x32_bf16 v[140:143], v[52:55], v[88:91], v[140:143]
    v_mfma_f32_16x16x32_bf16 v[144:147], v[56:59], v[80:83], v[144:147]
    v_mfma_f32_16x16x32_bf16 v[148:151], v[56:59], v[84:87], v[148:151]
    v_mfma_f32_16x16x32_bf16 v[152:155], v[56:59], v[88:91], v[152:155]
    v_mfma_f32_16x16x32_bf16 v[156:159], v[60:63], v[80:83], v[156:159]
    v_mfma_f32_16x16x32_bf16 v[160:163], v[60:63], v[84:87], v[160:163]
    v_mfma_f32_16x16x32_bf16 v[164:167], v[60:63], v[88:91], v[164:167]
    v_mfma_f32_16x16x32_bf16 v[168:171], v[64:67], v[80:83], v[168:171]
    v_mfma_f32_16x16x32_bf16 v[172:175], v[64:67], v[84:87], v[172:175]
    v_mfma_f32_16x16x32_bf16 v[176:179], v[64:67], v[88:91], v[176:179]
    s_waitcnt lgkmcnt(0)
    s_add_u32 s64, s75, 1
    s_sub_u32 s71, s64, 11
    s_cmp_ge_u32 s64, 11
    s_cselect_b32 s64, s71, s64
    s_lshl_b32 s64, s64, 2
    s_add_u32 s64, s64, s77
    s_lshl_b32 s64, s64, 17
    s_add_u32 m0, s89, 16384
    s_nop 0
    buffer_load_dwordx4 v193, s[36:39], s64 offen lds
    s_add_u32 m0, s89, 17408
    s_add_u32 s64, s64, 32768
    buffer_load_dwordx4 v193, s[36:39], s64 offen lds
    s_add_u32 m0, s89, 18432
    s_add_u32 s64, s64, 32768
    buffer_load_dwordx4 v193, s[36:39], s64 offen lds
    s_add_u32 m0, s89, 19456
    s_add_u32 s64, s64, 32768
    buffer_load_dwordx4 v193, s[36:39], s64 offen lds
    s_waitcnt vmcnt(11)
    ds_read_b64_tr_b16 v[52:53], v201 offset:0
    ds_read_b64_tr_b16 v[54:55], v201 offset:512
    ds_read_b64_tr_b16 v[56:57], v202 offset:0
    ds_read_b64_tr_b16 v[58:59], v202 offset:512
    ds_read_b64_tr_b16 v[60:61], v203 offset:0
    ds_read_b64_tr_b16 v[62:63], v203 offset:512
    ds_read_b64_tr_b16 v[64:65], v204 offset:0
    ds_read_b64_tr_b16 v[66:67], v204 offset:512
    v_mfma_f32_16x16x32_bf16 v[132:135], v[36:39], v[92:95], v[132:135]
    v_mfma_f32_16x16x32_bf16 v[136:139], v[36:39], v[96:99], v[136:139]
    v_mfma_f32_16x16x32_bf16 v[140:143], v[36:39], v[100:103], v[140:143]
    v_mfma_f32_16x16x32_bf16 v[144:147], v[40:43], v[92:95], v[144:147]
    v_mfma_f32_16x16x32_bf16 v[148:151], v[40:43], v[96:99], v[148:151]
    v_mfma_f32_16x16x32_bf16 v[152:155], v[40:43], v[100:103], v[152:155]
    v_mfma_f32_16x16x32_bf16 v[156:159], v[44:47], v[92:95], v[156:159]
    v_mfma_f32_16x16x32_bf16 v[160:163], v[44:47], v[96:99], v[160:163]
    v_mfma_f32_16x16x32_bf16 v[164:167], v[44:47], v[100:103], v[164:167]
    v_mfma_f32_16x16x32_bf16 v[168:171], v[48:51], v[92:95], v[168:171]
    v_mfma_f32_16x16x32_bf16 v[172:175], v[48:51], v[96:99], v[172:175]
    v_mfma_f32_16x16x32_bf16 v[176:179], v[48:51], v[100:103], v[176:179]
    s_waitcnt lgkmcnt(0)
    s_add_u32 s64, s75, 2
    s_sub_u32 s71, s64, 11
    s_cmp_ge_u32 s64, 11
    s_cselect_b32 s64, s71, s64
    s_lshl_b32 s64, s64, 2
    s_add_u32 s64, s64, s77
    s_lshl_b32 s64, s64, 17
    s_add_u32 m0, s89, 32768
    s_nop 0
    buffer_load_dwordx4 v193, s[36:39], s64 offen lds
    s_add_u32 m0, s89, 33792
    s_add_u32 s64, s64, 32768
    buffer_load_dwordx4 v193, s[36:39], s64 offen lds
    s_add_u32 m0, s89, 34816
    s_add_u32 s64, s64, 32768
    buffer_load_dwordx4 v193, s[36:39], s64 offen lds
    s_add_u32 m0, s89, 35840
    s_add_u32 s64, s64, 32768
    buffer_load_dwordx4 v193, s[36:39], s64 offen lds
    s_waitcnt vmcnt(12)
    v_mfma_f32_16x16x32_bf16 v[132:135], v[52:55], v[68:71], v[132:135]
    v_mfma_f32_16x16x32_bf16 v[136:139], v[52:55], v[72:75], v[136:139]
    v_mfma_f32_16x16x32_bf16 v[140:143], v[52:55], v[76:79], v[140:143]
    v_mfma_f32_16x16x32_bf16 v[144:147], v[56:59], v[68:71], v[144:147]
    v_mfma_f32_16x16x32_bf16 v[148:151], v[56:59], v[72:75], v[148:151]
    v_mfma_f32_16x16x32_bf16 v[152:155], v[56:59], v[76:79], v[152:155]
    v_mfma_f32_16x16x32_bf16 v[156:159], v[60:63], v[68:71], v[156:159]
    v_mfma_f32_16x16x32_bf16 v[160:163], v[60:63], v[72:75], v[160:163]
    v_mfma_f32_16x16x32_bf16 v[164:167], v[60:63], v[76:79], v[164:167]
    v_mfma_f32_16x16x32_bf16 v[168:171], v[64:67], v[68:71], v[168:171]
    v_mfma_f32_16x16x32_bf16 v[172:175], v[64:67], v[72:75], v[172:175]
    v_mfma_f32_16x16x32_bf16 v[176:179], v[64:67], v[76:79], v[176:179]
    ds_write_b128 v230, v[132:135] offset:0
    ds_write_b128 v230, v[136:139] offset:1024
    ds_write_b128 v230, v[140:143] offset:2048
    ds_write_b128 v230, v[144:147] offset:3072
    ds_write_b128 v230, v[148:151] offset:16384
    ds_write_b128 v230, v[152:155] offset:17408
    ds_write_b128 v230, v[156:159] offset:18432
    ds_write_b128 v230, v[160:163] offset:19456
    ds_write_b128 v230, v[164:167] offset:32768
    ds_write_b128 v230, v[168:171] offset:33792
    ds_write_b128 v230, v[172:175] offset:34816
    ds_write_b128 v230, v[176:179] offset:35840
    s_waitcnt lgkmcnt(0)
    s_mov_b64 exec, 1
    ds_add_u32 v22, v23 offset:12
    s_mov_b64 exec, -1
    v_lshlrev_b32 v236, 16, v228
    v_and_b32 v237, 0xffff0000, v228
    v_lshlrev_b32 v238, 16, v229
    v_and_b32 v239, 0xffff0000, v229
    s_mov_b32 s79, 3200000
lw_55:
    ds_read_b32 v5, v22 offset:12
    s_waitcnt lgkmcnt(0)
    v_readfirstlane_b32 s71, v5
    s_cmp_ge_u32 s71, 4
    s_cbranch_scc1 lwd_56
    s_sub_u32 s79, s79, 1
    s_cmp_lg_u32 s79, 0
    s_cbranch_scc1 lw_55
lwd_56:
    ds_read_b128 v[132:135], v231 offset:0
    ds_read_b128 v[144:147], v231 offset:4096
    ds_read_b128 v[156:159], v231 offset:8192
    ds_read_b128 v[168:171], v231 offset:12288
    ds_read_b128 v[136:139], v232 offset:0
    ds_read_b128 v[148:151], v232 offset:4096
    ds_read_b128 v[160:163], v232 offset:8192
    ds_read_b128 v[172:175], v232 offset:12288
    ds_read_b128 v[140:143], v233 offset:0
    ds_read_b128 v[152:155], v233 offset:4096
    ds_read_b128 v[164:167], v233 offset:8192
    ds_read_b128 v[176:179], v233 offset:12288
    s_waitcnt lgkmcnt(8)
    v_pk_add_f32 v[132:133], v[132:133], v[144:145]
    v_pk_add_f32 v[156:157], v[156:157], v[168:169]
    v_pk_add_f32 v[132:133], v[132:133], v[236:237]
    v_pk_add_f32 v[132:133], v[132:133], v[156:157]
    v_pk_add_f32 v[134:135], v[134:135], v[146:147]
    v_pk_add_f32 v[158:159], v[158:159], v[170:171]
    v_pk_add_f32 v[134:135], v[134:135], v[238:239]
    v_pk_add_f32 v[134:135], v[134:135], v[158:159]
    v_mul_f32 v36, v132, v132
    v_mul_f32 v37, v133, v133
    v_mul_f32 v38, v134, v134
    v_mul_f32 v39, v135, v135
    v_fma_f32 v36, v36, s69, v234
    v_fma_f32 v37, v37, s69, v234
    v_fma_f32 v38, v38, s69, v234
    v_fma_f32 v39, v39, s69, v234
    v_mul_f32 v36, v36, v132
    v_mul_f32 v37, v37, v133
    v_mul_f32 v38, v38, v134
    v_mul_f32 v39, v39, v135
    v_exp_f32 v36, v36
    v_exp_f32 v37, v37
    v_exp_f32 v38, v38
    v_exp_f32 v39, v39
    v_add_f32 v36, 1.0, v36
    v_add_f32 v37, 1.0, v37
    v_add_f32 v38, 1.0, v38
    v_add_f32 v39, 1.0, v39
    v_rcp_f32 v36, v36
    v_rcp_f32 v37, v37
    v_rcp_f32 v38, v38
    v_rcp_f32 v39, v39
    v_mul_f32 v132, v132, v36
    v_mul_f32 v133, v133, v37
    v_mul_f32 v134, v134, v38
    v_mul_f32 v135, v135, v39
    v_cvt_pk_bf16_f32 v40, v132, v133
    v_cvt_pk_bf16_f32 v41, v134, v135
    buffer_store_dwordx2 v[40:41], v240, s[44:47], s68 offen sc1
    s_waitcnt lgkmcnt(4)
    v_pk_add_f32 v[136:137], v[136:137], v[148:149]
    v_pk_add_f32 v[160:161], v[160:161], v[172:173]
    v_pk_add_f32 v[136:137], v[136:137], v[236:237]
    v_pk_add_f32 v[136:137], v[136:137], v[160:161]
    v_pk_add_f32 v[138:139], v[138:139], v[150:151]
    v_pk_add_f32 v[162:163], v[162:163], v[174:175]
    v_pk_add_f32 v[138:139], v[138:139], v[238:239]
    v_pk_add_f32 v[138:139], v[138:139], v[162:163]
    v_mul_f32 v36, v136, v136
    v_mul_f32 v37, v137, v137
    v_mul_f32 v38, v138, v138
    v_mul_f32 v39, v139, v139
    v_fma_f32 v36, v36, s69, v234
    v_fma_f32 v37, v37, s69, v234
    v_fma_f32 v38, v38, s69, v234
    v_fma_f32 v39, v39, s69, v234
    v_mul_f32 v36, v36, v136
    v_mul_f32 v37, v37, v137
    v_mul_f32 v38, v38, v138
    v_mul_f32 v39, v39, v139
    v_exp_f32 v36, v36
    v_exp_f32 v37, v37
    v_exp_f32 v38, v38
    v_exp_f32 v39, v39
    v_add_f32 v36, 1.0, v36
    v_add_f32 v37, 1.0, v37
    v_add_f32 v38, 1.0, v38
    v_add_f32 v39, 1.0, v39
    v_rcp_f32 v36, v36
    v_rcp_f32 v37, v37
    v_rcp_f32 v38, v38
    v_rcp_f32 v39, v39
    v_mul_f32 v136, v136, v36
    v_mul_f32 v137, v137, v37
    v_mul_f32 v138, v138, v38
    v_mul_f32 v139, v139, v39
    v_cvt_pk_bf16_f32 v42, v136, v137
    v_cvt_pk_bf16_f32 v43, v138, v139
    buffer_store_dwordx2 v[42:43], v241, s[44:47], s68 offen sc1
    s_waitcnt lgkmcnt(0)
    v_pk_add_f32 v[140:141], v[140:141], v[152:153]
    v_pk_add_f32 v[164:165], v[164:165], v[176:177]
    v_pk_add_f32 v[140:141], v[140:141], v[236:237]
    v_pk_add_f32 v[140:141], v[140:141], v[164:165]
    v_pk_add_f32 v[142:143], v[142:143], v[154:155]
    v_pk_add_f32 v[166:167], v[166:167], v[178:179]
    v_pk_add_f32 v[142:143], v[142:143], v[238:239]
    v_pk_add_f32 v[142:143], v[142:143], v[166:167]
    v_mul_f32 v36, v140, v140
    v_mul_f32 v37, v141, v141
    v_mul_f32 v38, v142, v142
    v_mul_f32 v39, v143, v143
    v_fma_f32 v36, v36, s69, v234
    v_fma_f32 v37, v37, s69, v234
    v_fma_f32 v38, v38, s69, v234
    v_fma_f32 v39, v39, s69, v234
    v_mul_f32 v36, v36, v140
    v_mul_f32 v37, v37, v141
    v_mul_f32 v38, v38, v142
    v_mul_f32 v39, v39, v143
    v_exp_f32 v36, v36
    v_exp_f32 v37, v37
    v_exp_f32 v38, v38
    v_exp_f32 v39, v39
    v_add_f32 v36, 1.0, v36
    v_add_f32 v37, 1.0, v37
    v_add_f32 v38, 1.0, v38
    v_add_f32 v39, 1.0, v39
    v_rcp_f32 v36, v36
    v_rcp_f32 v37, v37
    v_rcp_f32 v38, v38
    v_rcp_f32 v39, v39
    v_mul_f32 v140, v140, v36
    v_mul_f32 v141, v141, v37
    v_mul_f32 v142, v142, v38
    v_mul_f32 v143, v143, v39
    v_cvt_pk_bf16_f32 v44, v140, v141
    v_cvt_pk_bf16_f32 v45, v142, v143
    buffer_store_dwordx2 v[44:45], v242, s[44:47], s68 offen sc1
    s_waitcnt vmcnt(0)
    s_mov_b64 exec, 1
    ds_add_rtn_u32 v5, v22, v23 offset:36
    s_mul_i32 s64, s32, 3
    s_lshr_b32 s65, s31, 3
    s_add_u32 s64, s64, s65
    s_lshl_b32 s64, s64, 7
    s_and_b32 s65, s31, 7
    s_lshl_b32 s65, s65, 2
    s_add_u32 s64, s64, s65
    s_add_u32 s64, s64, 12873728
    s_waitcnt lgkmcnt(0)
    v_readfirstlane_b32 s65, v5
    s_cmp_lg_u32 s65, 3
    s_cbranch_scc1 f4_57
    s_mov_b64 exec, 1
    v_mov_b32 v5, s99
    buffer_store_dword v5, v16, s[56:59], s64 offen sc1
    s_mov_b64 exec, -1
f4_57:
    s_mov_b64 exec, -1
    s_mov_b32 s79, 3200000
lw_58:
    ds_read_b32 v5, v22 offset:36
    s_waitcnt lgkmcnt(0)
    v_readfirstlane_b32 s71, v5
    s_cmp_ge_u32 s71, 4
    s_cbranch_scc1 lwd_59
    s_sub_u32 s79, s79, 1
    s_cmp_lg_u32 s79, 0
    s_cbranch_scc1 lw_58
lwd_59:
    s_add_u32 s64, s75, 3
    s_sub_u32 s71, s64, 11
    s_cmp_ge_u32 s64, 11
    s_cselect_b32 s64, s71, s64
    s_lshl_b32 s64, s64, 2
    s_add_u32 s64, s64, s77
    s_lshl_b32 s64, s64, 17
    s_add_u32 m0, s89, 49152
    s_nop 0
    buffer_load_dwordx4 v193, s[36:39], s64 offen lds
    s_add_u32 m0, s89, 50176
    s_add_u32 s64, s64, 32768
    buffer_load_dwordx4 v193, s[36:39], s64 offen lds
    s_add_u32 m0, s89, 51200
    s_add_u32 s64, s64, 32768
    buffer_load_dwordx4 v193, s[36:39], s64 offen lds
    s_add_u32 m0, s89, 52224
    s_add_u32 s64, s64, 32768
    buffer_load_dwordx4 v193, s[36:39], s64 offen lds
    s_add_u32 s64, s75, 4
    s_sub_u32 s71, s64, 11
    s_cmp_ge_u32 s64, 11
    s_cselect_b32 s64, s71, s64
    s_lshl_b32 s64, s64, 2
    s_add_u32 s64, s64, s77
    s_lshl_b32 s64, s64, 17
    s_add_u32 m0, s89, 65536
    s_nop 0
    buffer_load_dwordx4 v193, s[36:39], s64 offen lds
    s_add_u32 m0, s89, 66560
    s_add_u32 s64, s64, 32768
    buffer_load_dwordx4 v193, s[36:39], s64 offen lds
    s_add_u32 m0, s89, 67584
    s_add_u32 s64, s64, 32768
    buffer_load_dwordx4 v193, s[36:39], s64 offen lds
    s_add_u32 m0, s89, 68608
    s_add_u32 s64, s64, 32768
    buffer_load_dwordx4 v193, s[36:39], s64 offen lds
    s_add_u32 s64, s75, 5
    s_sub_u32 s71, s64, 11
    s_cmp_ge_u32 s64, 11
    s_cselect_b32 s64, s71, s64
    s_lshl_b32 s64, s64, 2
    s_add_u32 s64, s64, s77
    s_lshl_b32 s64, s64, 17
    s_add_u32 m0, s89, 0
    s_nop 0
    buffer_load_dwordx4 v193, s[36:39], s64 offen lds
    s_add_u32 m0, s89, 1024
    s_add_u32 s64, s64, 32768
    buffer_load_dwordx4 v193, s[36:39], s64 offen lds
    s_add_u32 m0, s89, 2048
    s_add_u32 s64, s64, 32768
    buffer_load_dwordx4 v193, s[36:39], s64 offen lds
    s_add_u32 m0, s89, 3072
    s_add_u32 s64, s64, 32768
    buffer_load_dwordx4 v193, s[36:39], s64 offen lds
    s_add_u32 s64, s75, 6
    s_sub_u32 s71, s64, 11
    s_cmp_ge_u32 s64, 11
    s_cselect_b32 s64, s71, s64
    s_lshl_b32 s64, s64, 2
    s_add_u32 s64, s64, s77
    s_lshl_b32 s64, s64, 17
    s_add_u32 m0, s89, 98304
    s_nop 0
    buffer_load_dwordx4 v193, s[36:39], s64 offen lds
    s_add_u32 m0, s89, 99328
    s_add_u32 s64, s64, 32768
    buffer_load_dwordx4 v193, s[36:39], s64 offen lds
    s_add_u32 m0, s89, 100352
    s_add_u32 s64, s64, 32768
    buffer_load_dwordx4 v193, s[36:39], s64 offen lds
    s_add_u32 m0, s89, 101376
    s_add_u32 s64, s64, 32768
    buffer_load_dwordx4 v193, s[36:39], s64 offen lds
    s_add_u32 s64, s75, 7
    s_sub_u32 s71, s64, 11
    s_cmp_ge_u32 s64, 11
    s_cselect_b32 s64, s71, s64
    s_lshl_b32 s64, s64, 2
    s_add_u32 s64, s64, s77
    s_lshl_b32 s64, s64, 17
    s_add_u32 m0, s89, 114688
    s_nop 0
    buffer_load_dwordx4 v193, s[36:39], s64 offen lds
    s_add_u32 m0, s89, 115712
    s_add_u32 s64, s64, 32768
    buffer_load_dwordx4 v193, s[36:39], s64 offen lds
    s_add_u32 m0, s89, 116736
    s_add_u32 s64, s64, 32768
    buffer_load_dwordx4 v193, s[36:39], s64 offen lds
    s_add_u32 m0, s89, 117760
    s_add_u32 s64, s64, 32768
    buffer_load_dwordx4 v193, s[36:39], s64 offen lds
    s_add_u32 s64, s75, 8
    s_sub_u32 s71, s64, 11
    s_cmp_ge_u32 s64, 11
    s_cselect_b32 s64, s71, s64
    s_lshl_b32 s64, s64, 2
    s_add_u32 s64, s64, s77
    s_lshl_b32 s64, s64, 17
    s_add_u32 m0, s89, 131072
    s_nop 0
    buffer_load_dwordx4 v193, s[36:39], s64 offen lds
    s_add_u32 m0, s89, 132096
    s_add_u32 s64, s64, 32768
    buffer_load_dwordx4 v193, s[36:39], s64 offen lds
    s_add_u32 m0, s89, 133120
    s_add_u32 s64, s64, 32768
    buffer_load_dwordx4 v193, s[36:39], s64 offen lds
    s_add_u32 m0, s89, 134144
    s_add_u32 s64, s64, 32768
    buffer_load_dwordx4 v193, s[36:39], s64 offen lds
    s_branch L_fphase
L_nou:
    s_mov_b32 s79, 3200000
lw_60:
    ds_read_b32 v5, v22 offset:20
    s_waitcnt lgkmcnt(0)
    v_readfirstlane_b32 s71, v5
    s_cmp_ge_u32 s71, 1
    s_cbranch_scc1 lwd_61
    s_sleep 4
    s_sub_u32 s79, s79, 1
    s_cmp_lg_u32 s79, 0
    s_cbranch_scc1 lw_60
lwd_61:
    s_mov_b32 s99, s71
    s_and_b32 s3, s3, 0xf8
    s_cmp_lg_u32 s3, 8
    s_cbranch_scc1 pf_62
    v_lshrrev_b32 v5, 3, v4
    v_lshlrev_b32 v5, 12, v5
    v_and_b32 v6, 7, v4
    v_lshl_add_u32 v5, v6, 7, v5
    s_lshr_b32 s64, s2, 3
    s_mul_i32 s64, s64, 43
    s_lshr_b32 s64, s64, 1
    s_and_b32 s65, s2, 1
    s_mul_i32 s65, s65, 688
    s_add_u32 s64, s64, s65
    s_lshl_b32 s64, s64, 12
    s_bfe_u32 s65, s2, 0x20001
    s_lshl_b32 s65, s65, 10
    s_add_u32 s64, s64, s65
    buffer_load_dword v180, v5, s[36:39], s64 offen
    s_add_u32 s64, s64, 32768
    buffer_load_dword v181, v5, s[36:39], s64 offen
    s_add_u32 s64, s64, 32768
    buffer_load_dword v182, v5, s[36:39], s64 offen
    s_add_u32 s64, s64, 32768
    v_lshlrev_b32 v5, 7, v4
    s_lshl_b32 s64, s2, 11
    s_mov_b64 exec, 0xffff
    buffer_load_dword v183, v5, s[52:55], s64 offen
    s_mov_b64 exec, -1
pf_62:
    s_waitcnt lgkmcnt(0)
    s_mov_b64 exec, 1
    ds_add_u32 v22, v23 offset:48
    s_mov_b64 exec, -1
    s_cmp_lt_u32 s32, 8
    s_cbranch_scc1 sl_64
    s_mov_b32 s79, 3200000
lw_65:
    ds_read_b32 v5, v22 offset:44
    s_waitcnt lgkmcnt(0)
    v_readfirstlane_b32 s71, v5
    s_cmp_ge_u32 s71, 4
    s_cbranch_scc1 lwd_66
    s_sleep 16
    s_sub_u32 s79, s79, 1
    s_cmp_lg_u32 s79, 0
    s_cbranch_scc1 lw_65
lwd_66:
    s_branch nr_63
sl_64:
    s_lshl_b32 s66, s32, 1
    s_lshr_b32 s64, s77, 1
    s_add_u32 s66, s66, s64
    s_lshl_b32 s67, s66, 9
    s_add_u32 s67, s67, 12853248
    v_and_b32 v6, 0x1ff, v184
    s_and_b32 s68, s77, 1
    s_mul_i32 s69, s66, 81920
    s_add_u32 s69, s69, 13631488
    s_lshl_b32 s64, s68, 10
    v_add_u32 v201, s64, v14
    s_lshl_b32 s64, s68, 7
    s_add_u32 s64, s64, 2048
    v_and_b32 v202, 31, v4
    v_lshlrev_b32 v202, 2, v202
    v_add_u32 v202, s64, v202
    v_mov_b32 v132, 0
    v_mov_b32 v133, 0
    v_mov_b32 v134, 0
    v_mov_b32 v135, 0
    v_mov_b32 v136, 0
    v_mov_b32 v137, 0
    v_mov_b32 v138, 0
    v_mov_b32 v139, 0
    v_mov_b32 v140, 0
    s_mov_b32 s91, 0x00003f80
    s_mov_b32 s92, 0x3f800000
    v_mul_u32_u24 v8, 2560, v10
    v_add_u32 v202, v202, v8
    s_mov_b32 s79, 400000
tp_67:
    buffer_load_dwordx4 v[180:183], v6, s[56:59], s67 offen sc1
    s_waitcnt vmcnt(0)
tpc_69:
    v_xor_b32 v180, s99, v180
    v_xor_b32 v181, s99, v181
    v_xor_b32 v182, s99, v182
    v_xor_b32 v183, s99, v183
    v_or_b32 v180, v180, v181
    v_or_b32 v180, v180, v182
    v_or_b32 v180, v180, v183
    v_cmp_eq_u32 vcc, 0, v180
    s_cmp_eq_u64 vcc, exec
    s_cbranch_scc1 tpd_68
    s_sleep 2
    s_sub_u32 s79, s79, 1
    s_cmp_lg_u32 s79, 0
    s_cbranch_scc1 tp_67
tpd_68:
    buffer_load_dwordx4 v[68:71], v201, s[56:59], s69 offen sc1
    buffer_load_dword v212, v202, s[56:59], s69 offen sc1
    s_add_u32 s69, s69, 2560
    buffer_load_dwordx4 v[72:75], v201, s[56:59], s69 offen sc1
    s_add_u32 s69, s69, 2560
    buffer_load_dwordx4 v[76:79], v201, s[56:59], s69 offen sc1
    buffer_load_dword v213, v202, s[56:59], s69 offen sc1
    s_add_u32 s69, s69, 2560
    buffer_load_dwordx4 v[80:83], v201, s[56:59], s69 offen sc1
    s_add_u32 s69, s69, 2560
    buffer_load_dwordx4 v[84:87], v201, s[56:59], s69 offen sc1
    buffer_load_dword v214, v202, s[56:59], s69 offen sc1
    s_add_u32 s69, s69, 2560
    buffer_load_dwordx4 v[88:91], v201, s[56:59], s69 offen sc1
    s_add_u32 s69, s69, 2560
    buffer_load_dwordx4 v[92:95], v201, s[56:59], s69 offen sc1
    buffer_load_dword v215, v202, s[56:59], s69 offen sc1
    s_add_u32 s69, s69, 2560
    buffer_load_dwordx4 v[96:99], v201, s[56:59], s69 offen sc1
    s_add_u32 s69, s69, 2560
    buffer_load_dwordx4 v[100:103], v201, s[56:59], s69 offen sc1
    buffer_load_dword v216, v202, s[56:59], s69 offen sc1
    s_add_u32 s69, s69, 2560
    buffer_load_dwordx4 v[104:107], v201, s[56:59], s69 offen sc1
    s_add_u32 s69, s69, 2560
    buffer_load_dwordx4 v[108:111], v201, s[56:59], s69 offen sc1
    buffer_load_dword v217, v202, s[56:59], s69 offen sc1
    s_add_u32 s69, s69, 2560
    buffer_load_dwordx4 v[112:115], v201, s[56:59], s69 offen sc1
    s_add_u32 s69, s69, 2560
    buffer_load_dwordx4 v[116:119], v201, s[56:59], s69 offen sc1
    buffer_load_dword v218, v202, s[56:59], s69 offen sc1
    s_add_u32 s69, s69, 2560
    buffer_load_dwordx4 v[120:123], v201, s[56:59], s69 offen sc1
    s_add_u32 s69, s69, 2560
    buffer_load_dwordx4 v[124:127], v201, s[56:59], s69 offen sc1
    buffer_load_dword v219, v202, s[56:59], s69 offen sc1
    s_add_u32 s69, s69, 2560
    buffer_load_dwordx4 v[128:131], v201, s[56:59], s69 offen sc1
    s_add_u32 s69, s69, 2560
    buffer_load_dwordx4 v[36:39], v201, s[56:59], s69 offen sc1
    buffer_load_dword v220, v202, s[56:59], s69 offen sc1
    s_add_u32 s69, s69, 2560
    buffer_load_dwordx4 v[40:43], v201, s[56:59], s69 offen sc1
    s_add_u32 s69, s69, 2560
    buffer_load_dwordx4 v[44:47], v201, s[56:59], s69 offen sc1
    buffer_load_dword v221, v202, s[56:59], s69 offen sc1
    s_add_u32 s69, s69, 2560
    buffer_load_dwordx4 v[48:51], v201, s[56:59], s69 offen sc1
    s_add_u32 s69, s69, 2560
    buffer_load_dwordx4 v[52:55], v201, s[56:59], s69 offen sc1
    buffer_load_dword v222, v202, s[56:59], s69 offen sc1
    s_add_u32 s69, s69, 2560
    buffer_load_dwordx4 v[56:59], v201, s[56:59], s69 offen sc1
    s_add_u32 s69, s69, 2560
    buffer_load_dwordx4 v[60:63], v201, s[56:59], s69 offen sc1
    buffer_load_dword v223, v202, s[56:59], s69 offen sc1
    s_add_u32 s69, s69, 2560
    buffer_load_dwordx4 v[64:67], v201, s[56:59], s69 offen sc1
    s_add_u32 s69, s69, 2560
    buffer_load_dwordx4 v[148:151], v201, s[56:59], s69 offen sc1
    buffer_load_dword v224, v202, s[56:59], s69 offen sc1
    s_add_u32 s69, s69, 2560
    buffer_load_dwordx4 v[152:155], v201, s[56:59], s69 offen sc1
    s_add_u32 s69, s69, 2560
    buffer_load_dwordx4 v[156:159], v201, s[56:59], s69 offen sc1
    buffer_load_dword v225, v202, s[56:59], s69 offen sc1
    s_add_u32 s69, s69, 2560
    buffer_load_dwordx4 v[160:163], v201, s[56:59], s69 offen sc1
    s_add_u32 s69, s69, 2560
    buffer_load_dwordx4 v[164:167], v201, s[56:59], s69 offen sc1
    buffer_load_dword v226, v202, s[56:59], s69 offen sc1
    s_add_u32 s69, s69, 2560
    buffer_load_dwordx4 v[168:171], v201, s[56:59], s69 offen sc1
    s_add_u32 s69, s69, 2560
    buffer_load_dwordx4 v[172:175], v201, s[56:59], s69 offen sc1
    buffer_load_dword v227, v202, s[56:59], s69 offen sc1
    s_add_u32 s69, s69, 2560
    buffer_load_dwordx4 v[176:179], v201, s[56:59], s69 offen sc1
    s_add_u32 s69, s69, 2560
    s_waitcnt vmcnt(42)
    v_dot2c_f32_bf16 v132, s91, v68
    v_dot2c_f32_bf16 v133, s92, v68
    v_dot2c_f32_bf16 v134, s91, v69
    v_dot2c_f32_bf16 v135, s92, v69
    v_dot2c_f32_bf16 v136, s91, v70
    v_dot2c_f32_bf16 v137, s92, v70
    v_dot2c_f32_bf16 v138, s91, v71
    v_dot2c_f32_bf16 v139, s92, v71
    v_add_f32 v140, v140, v212
    v_dot2c_f32_bf16 v132, s91, v72
    v_dot2c_f32_bf16 v133, s92, v72
    v_dot2c_f32_bf16 v134, s91, v73
    v_dot2c_f32_bf16 v135, s92, v73
    v_dot2c_f32_bf16 v136, s91, v74
    v_dot2c_f32_bf16 v137, s92, v74
    v_dot2c_f32_bf16 v138, s91, v75
    v_dot2c_f32_bf16 v139, s92, v75
    v_dot2c_f32_bf16 v132, s91, v76
    v_dot2c_f32_bf16 v133, s92, v76
    v_dot2c_f32_bf16 v134, s91, v77
    v_dot2c_f32_bf16 v135, s92, v77
    v_dot2c_f32_bf16 v136, s91, v78
    v_dot2c_f32_bf16 v137, s92, v78
    v_dot2c_f32_bf16 v138, s91, v79
    v_dot2c_f32_bf16 v139, s92, v79
    v_add_f32 v140, v140, v213
    v_dot2c_f32_bf16 v132, s91, v80
    v_dot2c_f32_bf16 v133, s92, v80
    v_dot2c_f32_bf16 v134, s91, v81
    v_dot2c_f32_bf16 v135, s92, v81
    v_dot2c_f32_bf16 v136, s91, v82
    v_dot2c_f32_bf16 v137, s92, v82
    v_dot2c_f32_bf16 v138, s91, v83
    v_dot2c_f32_bf16 v139, s92, v83
    s_waitcnt vmcnt(36)
    v_dot2c_f32_bf16 v132, s91, v84
    v_dot2c_f32_bf16 v133, s92, v84
    v_dot2c_f32_bf16 v134, s91, v85
    v_dot2c_f32_bf16 v135, s92, v85
    v_dot2c_f32_bf16 v136, s91, v86
    v_dot2c_f32_bf16 v137, s92, v86
    v_dot2c_f32_bf16 v138, s91, v87
    v_dot2c_f32_bf16 v139, s92, v87
    v_add_f32 v140, v140, v214
    v_dot2c_f32_bf16 v132, s91, v88
    v_dot2c_f32_bf16 v133, s92, v88
    v_dot2c_f32_bf16 v134, s91, v89
    v_dot2c_f32_bf16 v135, s92, v89
    v_dot2c_f32_bf16 v136, s91, v90
    v_dot2c_f32_bf16 v137, s92, v90
    v_dot2c_f32_bf16 v138, s91, v91
    v_dot2c_f32_bf16 v139, s92, v91
    v_dot2c_f32_bf16 v132, s91, v92
    v_dot2c_f32_bf16 v133, s92, v92
    v_dot2c_f32_bf16 v134, s91, v93
    v_dot2c_f32_bf16 v135, s92, v93
    v_dot2c_f32_bf16 v136, s91, v94
    v_dot2c_f32_bf16 v137, s92, v94
    v_dot2c_f32_bf16 v138, s91, v95
    v_dot2c_f32_bf16 v139, s92, v95
    v_add_f32 v140, v140, v215
    v_dot2c_f32_bf16 v132, s91, v96
    v_dot2c_f32_bf16 v133, s92, v96
    v_dot2c_f32_bf16 v134, s91, v97
    v_dot2c_f32_bf16 v135, s92, v97
    v_dot2c_f32_bf16 v136, s91, v98
    v_dot2c_f32_bf16 v137, s92, v98
    v_dot2c_f32_bf16 v138, s91, v99
    v_dot2c_f32_bf16 v139, s92, v99
    s_waitcnt vmcnt(30)
    v_dot2c_f32_bf16 v132, s91, v100
    v_dot2c_f32_bf16 v133, s92, v100
    v_dot2c_f32_bf16 v134, s91, v101
    v_dot2c_f32_bf16 v135, s92, v101
    v_dot2c_f32_bf16 v136, s91, v102
    v_dot2c_f32_bf16 v137, s92, v102
    v_dot2c_f32_bf16 v138, s91, v103
    v_dot2c_f32_bf16 v139, s92, v103
    v_add_f32 v140, v140, v216
    v_dot2c_f32_bf16 v132, s91, v104
    v_dot2c_f32_bf16 v133, s92, v104
    v_dot2c_f32_bf16 v134, s91, v105
    v_dot2c_f32_bf16 v135, s92, v105
    v_dot2c_f32_bf16 v136, s91, v106
    v_dot2c_f32_bf16 v137, s92, v106
    v_dot2c_f32_bf16 v138, s91, v107
    v_dot2c_f32_bf16 v139, s92, v107
    v_dot2c_f32_bf16 v132, s91, v108
    v_dot2c_f32_bf16 v133, s92, v108
    v_dot2c_f32_bf16 v134, s91, v109
    v_dot2c_f32_bf16 v135, s92, v109
    v_dot2c_f32_bf16 v136, s91, v110
    v_dot2c_f32_bf16 v137, s92, v110
    v_dot2c_f32_bf16 v138, s91, v111
    v_dot2c_f32_bf16 v139, s92, v111
    v_add_f32 v140, v140, v217
    v_dot2c_f32_bf16 v132, s91, v112
    v_dot2c_f32_bf16 v133, s92, v112
    v_dot2c_f32_bf16 v134, s91, v113
    v_dot2c_f32_bf16 v135, s92, v113
    v_dot2c_f32_bf16 v136, s91, v114
    v_dot2c_f32_bf16 v137, s92, v114
    v_dot2c_f32_bf16 v138, s91, v115
    v_dot2c_f32_bf16 v139, s92, v115
    s_waitcnt vmcnt(24)
    v_dot2c_f32_bf16 v132, s91, v116
    v_dot2c_f32_bf16 v133, s92, v116
    v_dot2c_f32_bf16 v134, s91, v117
    v_dot2c_f32_bf16 v135, s92, v117
    v_dot2c_f32_bf16 v136, s91, v118
    v_dot2c_f32_bf16 v137, s92, v118
    v_dot2c_f32_bf16 v138, s91, v119
    v_dot2c_f32_bf16 v139, s92, v119
    v_add_f32 v140, v140, v218
    v_dot2c_f32_bf16 v132, s91, v120
    v_dot2c_f32_bf16 v133, s92, v120
    v_dot2c_f32_bf16 v134, s91, v121
    v_dot2c_f32_bf16 v135, s92, v121
    v_dot2c_f32_bf16 v136, s91, v122
    v_dot2c_f32_bf16 v137, s92, v122
    v_dot2c_f32_bf16 v138, s91, v123
    v_dot2c_f32_bf16 v139, s92, v123
    v_dot2c_f32_bf16 v132, s91, v124
    v_dot2c_f32_bf16 v133, s92, v124
    v_dot2c_f32_bf16 v134, s91, v125
    v_dot2c_f32_bf16 v135, s92, v125
    v_dot2c_f32_bf16 v136, s91, v126
    v_dot2c_f32_bf16 v137, s92, v126
    v_dot2c_f32_bf16 v138, s91, v127
    v_dot2c_f32_bf16 v139, s92, v127
    v_add_f32 v140, v140, v219
    v_dot2c_f32_bf16 v132, s91, v128
    v_dot2c_f32_bf16 v133, s92, v128
    v_dot2c_f32_bf16 v134, s91, v129
    v_dot2c_f32_bf16 v135, s92, v129
    v_dot2c_f32_bf16 v136, s91, v130
    v_dot2c_f32_bf16 v137, s92, v130
    v_dot2c_f32_bf16 v138, s91, v131
    v_dot2c_f32_bf16 v139, s92, v131
    s_waitcnt vmcnt(18)
    v_dot2c_f32_bf16 v132, s91, v36
    v_dot2c_f32_bf16 v133, s92, v36
    v_dot2c_f32_bf16 v134, s91, v37
    v_dot2c_f32_bf16 v135, s92, v37
    v_dot2c_f32_bf16 v136, s91, v38
    v_dot2c_f32_bf16 v137, s92, v38
    v_dot2c_f32_bf16 v138, s91, v39
    v_dot2c_f32_bf16 v139, s92, v39
    v_add_f32 v140, v140, v220
    v_dot2c_f32_bf16 v132, s91, v40
    v_dot2c_f32_bf16 v133, s92, v40
    v_dot2c_f32_bf16 v134, s91, v41
    v_dot2c_f32_bf16 v135, s92, v41
    v_dot2c_f32_bf16 v136, s91, v42
    v_dot2c_f32_bf16 v137, s92, v42
    v_dot2c_f32_bf16 v138, s91, v43
    v_dot2c_f32_bf16 v139, s92, v43
    v_dot2c_f32_bf16 v132, s91, v44
    v_dot2c_f32_bf16 v133, s92, v44
    v_dot2c_f32_bf16 v134, s91, v45
    v_dot2c_f32_bf16 v135, s92, v45
    v_dot2c_f32_bf16 v136, s91, v46
    v_dot2c_f32_bf16 v137, s92, v46
    v_dot2c_f32_bf16 v138, s91, v47
    v_dot2c_f32_bf16 v139, s92, v47
    v_add_f32 v140, v140, v221
    v_dot2c_f32_bf16 v132, s91, v48
    v_dot2c_f32_bf16 v133, s92, v48
    v_dot2c_f32_bf16 v134, s91, v49
    v_dot2c_f32_bf16 v135, s92, v49
    v_dot2c_f32_bf16 v136, s91, v50
    v_dot2c_f32_bf16 v137, s92, v50
    v_dot2c_f32_bf16 v138, s91, v51
    v_dot2c_f32_bf16 v139, s92, v51
    s_waitcnt vmcnt(12)
    v_dot2c_f32_bf16 v132, s91, v52
    v_dot2c_f32_bf16 v133, s92, v52
    v_dot2c_f32_bf16 v134, s91, v53
    v_dot2c_f32_bf16 v135, s92, v53
    v_dot2c_f32_bf16 v136, s91, v54
    v_dot2c_f32_bf16 v137, s92, v54
    v_dot2c_f32_bf16 v138, s91, v55
    v_dot2c_f32_bf16 v139, s92, v55
    v_add_f32 v140, v140, v222
    v_dot2c_f32_bf16 v132, s91, v56
    v_dot2c_f32_bf16 v133, s92, v56
    v_dot2c_f32_bf16 v134, s91, v57
    v_dot2c_f32_bf16 v135, s92, v57
    v_dot2c_f32_bf16 v136, s91, v58
    v_dot2c_f32_bf16 v137, s92, v58
    v_dot2c_f32_bf16 v138, s91, v59
    v_dot2c_f32_bf16 v139, s92, v59
    v_dot2c_f32_bf16 v132, s91, v60
    v_dot2c_f32_bf16 v133, s92, v60
    v_dot2c_f32_bf16 v134, s91, v61
    v_dot2c_f32_bf16 v135, s92, v61
    v_dot2c_f32_bf16 v136, s91, v62
    v_dot2c_f32_bf16 v137, s92, v62
    v_dot2c_f32_bf16 v138, s91, v63
    v_dot2c_f32_bf16 v139, s92, v63
    v_add_f32 v140, v140, v223
    v_dot2c_f32_bf16 v132, s91, v64
    v_dot2c_f32_bf16 v133, s92, v64
    v_dot2c_f32_bf16 v134, s91, v65
    v_dot2c_f32_bf16 v135, s92, v65
    v_dot2c_f32_bf16 v136, s91, v66
    v_dot2c_f32_bf16 v137, s92, v66
    v_dot2c_f32_bf16 v138, s91, v67
    v_dot2c_f32_bf16 v139, s92, v67
    s_waitcnt vmcnt(6)
    v_dot2c_f32_bf16 v132, s91, v148
    v_dot2c_f32_bf16 v133, s92, v148
    v_dot2c_f32_bf16 v134, s91, v149
    v_dot2c_f32_bf16 v135, s92, v149
    v_dot2c_f32_bf16 v136, s91, v150
    v_dot2c_f32_bf16 v137, s92, v150
    v_dot2c_f32_bf16 v138, s91, v151
    v_dot2c_f32_bf16 v139, s92, v151
    v_add_f32 v140, v140, v224
    v_dot2c_f32_bf16 v132, s91, v152
    v_dot2c_f32_bf16 v133, s92, v152
    v_dot2c_f32_bf16 v134, s91, v153
    v_dot2c_f32_bf16 v135, s92, v153
    v_dot2c_f32_bf16 v136, s91, v154
    v_dot2c_f32_bf16 v137, s92, v154
    v_dot2c_f32_bf16 v138, s91, v155
    v_dot2c_f32_bf16 v139, s92, v155
    v_dot2c_f32_bf16 v132, s91, v156
    v_dot2c_f32_bf16 v133, s92, v156
    v_dot2c_f32_bf16 v134, s91, v157
    v_dot2c_f32_bf16 v135, s92, v157
    v_dot2c_f32_bf16 v136, s91, v158
    v_dot2c_f32_bf16 v137, s92, v158
    v_dot2c_f32_bf16 v138, s91, v159
    v_dot2c_f32_bf16 v139, s92, v159
    v_add_f32 v140, v140, v225
    v_dot2c_f32_bf16 v132, s91, v160
    v_dot2c_f32_bf16 v133, s92, v160
    v_dot2c_f32_bf16 v134, s91, v161
    v_dot2c_f32_bf16 v135, s92, v161
    v_dot2c_f32_bf16 v136, s91, v162
    v_dot2c_f32_bf16 v137, s92, v162
    v_dot2c_f32_bf16 v138, s91, v163
    v_dot2c_f32_bf16 v139, s92, v163
    s_waitcnt vmcnt(0)
    v_dot2c_f32_bf16 v132, s91, v164
    v_dot2c_f32_bf16 v133, s92, v164
    v_dot2c_f32_bf16 v134, s91, v165
    v_dot2c_f32_bf16 v135, s92, v165
    v_dot2c_f32_bf16 v136, s91, v166
    v_dot2c_f32_bf16 v137, s92, v166
    v_dot2c_f32_bf16 v138, s91, v167
    v_dot2c_f32_bf16 v139, s92, v167
    v_add_f32 v140, v140, v226
    v_dot2c_f32_bf16 v132, s91, v168
    v_dot2c_f32_bf16 v133, s92, v168
    v_dot2c_f32_bf16 v134, s91, v169
    v_dot2c_f32_bf16 v135, s92, v169
    v_dot2c_f32_bf16 v136, s91, v170
    v_dot2c_f32_bf16 v137, s92, v170
    v_dot2c_f32_bf16 v138, s91, v171
    v_dot2c_f32_bf16 v139, s92, v171
    v_dot2c_f32_bf16 v132, s91, v172
    v_dot2c_f32_bf16 v133, s92, v172
    v_dot2c_f32_bf16 v134, s91, v173
    v_dot2c_f32_bf16 v135, s92, v173
    v_dot2c_f32_bf16 v136, s91, v174
    v_dot2c_f32_bf16 v137, s92, v174
    v_dot2c_f32_bf16 v138, s91, v175
    v_dot2c_f32_bf16 v139, s92, v175
    v_add_f32 v140, v140, v227
    v_dot2c_f32_bf16 v132, s91, v176
    v_dot2c_f32_bf16 v133, s92, v176
    v_dot2c_f32_bf16 v134, s91, v177
    v_dot2c_f32_bf16 v135, s92, v177
    v_dot2c_f32_bf16 v136, s91, v178
    v_dot2c_f32_bf16 v137, s92, v178
    v_dot2c_f32_bf16 v138, s91, v179
    v_dot2c_f32_bf16 v139, s92, v179
    v_mov_b32 v141, v140
    s_nop 1
    v_permlane32_swap_b32 v140, v141
    v_add_f32 v140, v140, v141
    v_and_b32 v5, 31, v4
    v_lshlrev_b32 v5, 1, v5
    v_add_u32 v5, s89, v5
    v_lshl_add_u32 v6, v10, 8, v5
    v_cvt_pk_bf16_f32 v148, v132, v132
    v_cvt_pk_bf16_f32 v149, v133, v133
    v_cvt_pk_bf16_f32 v150, v134, v134
    v_cvt_pk_bf16_f32 v151, v135, v135
    v_cvt_pk_bf16_f32 v152, v136, v136
    v_cvt_pk_bf16_f32 v153, v137, v137
    v_cvt_pk_bf16_f32 v154, v138, v138
    v_cvt_pk_bf16_f32 v155, v139, v139
    v_cvt_pk_bf16_f32 v156, v140, v140
    ds_write_b16 v6, v148 offset:0
    ds_write_b16 v6, v149 offset:64
    ds_write_b16 v6, v150 offset:128
    ds_write_b16 v6, v151 offset:192
    ds_write_b16 v6, v152 offset:512
    ds_write_b16 v6, v153 offset:576
    ds_write_b16 v6, v154 offset:640
    ds_write_b16 v6, v155 offset:704
    ds_write_b16 v5, v156 offset:1024
    v_and_b32 v5, 15, v4
    v_lshlrev_b32 v6, 6, v5
    v_lshl_add_u32 v6, v11, 4, v6
    v_add_u32 v6, s89, v6
    v_add_u32 v8, s89, v14
    s_waitcnt lgkmcnt(0)
    ds_read_b128 v[132:135], v6
    ds_read_b128 v[136:139], v8 offset:1024
    v_lshlrev_b32 v5, 4, v5
    v_lshl_add_u32 v5, v11, 9, v5
    s_lshl_b32 s64, s66, 12
    s_add_u32 s64, s64, 13107200
    s_lshl_b32 s65, s68, 6
    s_add_u32 s65, s65, s64
    s_lshl_b32 s68, s68, 8
    s_add_u32 s64, s64, s68
    s_waitcnt lgkmcnt(0)
    buffer_store_dwordx4 v[132:135], v5, s[56:59], s64 offen sc1
    s_mov_b64 exec, 15
    buffer_store_dwordx4 v[136:139], v14, s[56:59], s65 offen offset:2048 sc1
    s_lshl_b32 s64, s32, 7
    s_add_u32 s64, s64, 12881920
    s_waitcnt vmcnt(0)
    s_mov_b64 exec, 1
    ds_add_rtn_u32 v5, v22, v23 offset:36
    s_waitcnt lgkmcnt(0)
    v_readfirstlane_b32 s65, v5
    s_mov_b64 exec, -1
    s_cmp_lg_u32 s65, 3
    s_cbranch_scc1 nr_63
    s_mov_b64 exec, 1
    v_mov_b32 v5, s99
    buffer_store_dword v5, v16, s[56:59], s64 offen sc1
    s_mov_b64 exec, -1
nr_63:
    s_mov_b32 s79, 3200000
lw_70:
    ds_read_b32 v5, v22 offset:0
    s_waitcnt lgkmcnt(0)
    v_readfirstlane_b32 s71, v5
    s_cmp_ge_u32 s71, 4
    s_cbranch_scc1 lwd_71
    s_sleep 4
    s_sub_u32 s79, s79, 1
    s_cmp_lg_u32 s79, 0
    s_cbranch_scc1 lw_70
lwd_71:
    s_add_u32 s64, s75, 0
    s_sub_u32 s71, s64, 11
    s_cmp_ge_u32 s64, 11
    s_cselect_b32 s64, s71, s64
    s_lshl_b32 s64, s64, 2
    s_add_u32 s64, s64, s77
    s_lshl_b32 s64, s64, 17
    s_add_u32 m0, s89, 81920
    s_nop 0
    buffer_load_dwordx4 v193, s[36:39], s64 offen lds
    s_add_u32 m0, s89, 82944
    s_add_u32 s64, s64, 32768
    buffer_load_dwordx4 v193, s[36:39], s64 offen lds
    s_add_u32 m0, s89, 83968
    s_add_u32 s64, s64, 32768
    buffer_load_dwordx4 v193, s[36:39], s64 offen lds
    s_add_u32 m0, s89, 84992
    s_add_u32 s64, s64, 32768
    buffer_load_dwordx4 v193, s[36:39], s64 offen lds
    s_add_u32 s64, s75, 1
    s_sub_u32 s71, s64, 11
    s_cmp_ge_u32 s64, 11
    s_cselect_b32 s64, s71, s64
    s_lshl_b32 s64, s64, 2
    s_add_u32 s64, s64, s77
    s_lshl_b32 s64, s64, 17
    s_add_u32 m0, s89, 16384
    s_nop 0
    buffer_load_dwordx4 v193, s[36:39], s64 offen lds
    s_add_u32 m0, s89, 17408
    s_add_u32 s64, s64, 32768
    buffer_load_dwordx4 v193, s[36:39], s64 offen lds
    s_add_u32 m0, s89, 18432
    s_add_u32 s64, s64, 32768
    buffer_load_dwordx4 v193, s[36:39], s64 offen lds
    s_add_u32 m0, s89, 19456
    s_add_u32 s64, s64, 32768
    buffer_load_dwordx4 v193, s[36:39], s64 offen lds
    s_add_u32 s64, s75, 2
    s_sub_u32 s71, s64, 11
    s_cmp_ge_u32 s64, 11
    s_cselect_b32 s64, s71, s64
    s_lshl_b32 s64, s64, 2
    s_add_u32 s64, s64, s77
    s_lshl_b32 s64, s64, 17
    s_add_u32 m0, s89, 32768
    s_nop 0
    buffer_load_dwordx4 v193, s[36:39], s64 offen lds
    s_add_u32 m0, s89, 33792
    s_add_u32 s64, s64, 32768
    buffer_load_dwordx4 v193, s[36:39], s64 offen lds
    s_add_u32 m0, s89, 34816
    s_add_u32 s64, s64, 32768
    buffer_load_dwordx4 v193, s[36:39], s64 offen lds
    s_add_u32 m0, s89, 35840
    s_add_u32 s64, s64, 32768
    buffer_load_dwordx4 v193, s[36:39], s64 offen lds
    s_add_u32 s64, s75, 3
    s_sub_u32 s71, s64, 11
    s_cmp_ge_u32 s64, 11
    s_cselect_b32 s64, s71, s64
    s_lshl_b32 s64, s64, 2
    s_add_u32 s64, s64, s77
    s_lshl_b32 s64, s64, 17
    s_add_u32 m0, s89, 49152
    s_nop 0
    buffer_load_dwordx4 v193, s[36:39], s64 offen lds
    s_add_u32 m0, s89, 50176
    s_add_u32 s64, s64, 32768
    buffer_load_dwordx4 v193, s[36:39], s64 offen lds
    s_add_u32 m0, s89, 51200
    s_add_u32 s64, s64, 32768
    buffer_load_dwordx4 v193, s[36:39], s64 offen lds
    s_add_u32 m0, s89, 52224
    s_add_u32 s64, s64, 32768
    buffer_load_dwordx4 v193, s[36:39], s64 offen lds
    s_add_u32 s64, s75, 4
    s_sub_u32 s71, s64, 11
    s_cmp_ge_u32 s64, 11
    s_cselect_b32 s64, s71, s64
    s_lshl_b32 s64, s64, 2
    s_add_u32 s64, s64, s77
    s_lshl_b32 s64, s64, 17
    s_add_u32 m0, s89, 65536
    s_nop 0
    buffer_load_dwordx4 v193, s[36:39], s64 offen lds
    s_add_u32 m0, s89, 66560
    s_add_u32 s64, s64, 32768
    buffer_load_dwordx4 v193, s[36:39], s64 offen lds
    s_add_u32 m0, s89, 67584
    s_add_u32 s64, s64, 32768
    buffer_load_dwordx4 v193, s[36:39], s64 offen lds
    s_add_u32 m0, s89, 68608
    s_add_u32 s64, s64, 32768
    buffer_load_dwordx4 v193, s[36:39], s64 offen lds
    s_add_u32 s64, s75, 5
    s_sub_u32 s71, s64, 11
    s_cmp_ge_u32 s64, 11
    s_cselect_b32 s64, s71, s64
    s_lshl_b32 s64, s64, 2
    s_add_u32 s64, s64, s77
    s_lshl_b32 s64, s64, 17
    s_add_u32 m0, s89, 0
    s_nop 0
    buffer_load_dwordx4 v193, s[36:39], s64 offen lds
    s_add_u32 m0, s89, 1024
    s_add_u32 s64, s64, 32768
    buffer_load_dwordx4 v193, s[36:39], s64 offen lds
    s_add_u32 m0, s89, 2048
    s_add_u32 s64, s64, 32768
    buffer_load_dwordx4 v193, s[36:39], s64 offen lds
    s_add_u32 m0, s89, 3072
    s_add_u32 s64, s64, 32768
    buffer_load_dwordx4 v193, s[36:39], s64 offen lds
    s_add_u32 s64, s75, 6
    s_sub_u32 s71, s64, 11
    s_cmp_ge_u32 s64, 11
    s_cselect_b32 s64, s71, s64
    s_lshl_b32 s64, s64, 2
    s_add_u32 s64, s64, s77
    s_lshl_b32 s64, s64, 17
    s_add_u32 m0, s89, 98304
    s_nop 0
    buffer_load_dwordx4 v193, s[36:39], s64 offen lds
    s_add_u32 m0, s89, 99328
    s_add_u32 s64, s64, 32768
    buffer_load_dwordx4 v193, s[36:39], s64 offen lds
    s_add_u32 m0, s89, 100352
    s_add_u32 s64, s64, 32768
    buffer_load_dwordx4 v193, s[36:39], s64 offen lds
    s_add_u32 m0, s89, 101376
    s_add_u32 s64, s64, 32768
    buffer_load_dwordx4 v193, s[36:39], s64 offen lds
    s_add_u32 s64, s75, 7
    s_sub_u32 s71, s64, 11
    s_cmp_ge_u32 s64, 11
    s_cselect_b32 s64, s71, s64
    s_lshl_b32 s64, s64, 2
    s_add_u32 s64, s64, s77
    s_lshl_b32 s64, s64, 17
    s_add_u32 m0, s89, 114688
    s_nop 0
    buffer_load_dwordx4 v193, s[36:39], s64 offen lds
    s_add_u32 m0, s89, 115712
    s_add_u32 s64, s64, 32768
    buffer_load_dwordx4 v193, s[36:39], s64 offen lds
    s_add_u32 m0, s89, 116736
    s_add_u32 s64, s64, 32768
    buffer_load_dwordx4 v193, s[36:39], s64 offen lds
    s_add_u32 m0, s89, 117760
    s_add_u32 s64, s64, 32768
    buffer_load_dwordx4 v193, s[36:39], s64 offen lds
    s_add_u32 s64, s75, 8
    s_sub_u32 s71, s64, 11
    s_cmp_ge_u32 s64, 11
    s_cselect_b32 s64, s71, s64
    s_lshl_b32 s64, s64, 2
    s_add_u32 s64, s64, s77
    s_lshl_b32 s64, s64, 17
    s_add_u32 m0, s89, 131072
    s_nop 0
    buffer_load_dwordx4 v193, s[36:39], s64 offen lds
    s_add_u32 m0, s89, 132096
    s_add_u32 s64, s64, 32768
    buffer_load_dwordx4 v193, s[36:39], s64 offen lds
    s_add_u32 m0, s89, 133120
    s_add_u32 s64, s64, 32768
    buffer_load_dwordx4 v193, s[36:39], s64 offen lds
    s_add_u32 m0, s89, 134144
    s_add_u32 s64, s64, 32768
    buffer_load_dwordx4 v193, s[36:39], s64 offen lds
    s_waitcnt vmcnt(0)
L_fphase:
    s_waitcnt lgkmcnt(0)
    s_mov_b64 exec, 1
    ds_add_u32 v22, v23 offset:56
    s_mov_b64 exec, -1
    s_lshl_b32 s69, s33, 11
    s_add_u32 s69, s69, 8388608
    s_lshl_b32 s70, s34, 11
    s_mov_b32 s40, s4
    s_mov_b32 s41, s5
    s_mov_b32 s42, 0x200000
    s_mov_b32 s43, 0x20000
    s_mov_b32 s48, s20
    s_mov_b32 s49, s21
    s_mov_b32 s50, 0x1000
    s_mov_b32 s51, 0x20000
    s_and_b32 s64, s77, 1
    s_lshl_b32 s64, s64, 5
    s_lshl_b32 s65, s33, 6
    s_add_u32 s64, s64, s65
    v_and_b32 v5, 31, v4
    v_add_u32 v5, s64, v5
    s_lshr_b32 s64, s77, 1
    s_lshl_b32 s64, s64, 6
    s_lshl_b32 s65, s34, 7
    s_add_u32 s64, s64, s65
    v_lshlrev_b32 v253, 10, v5
    v_lshl_add_u32 v253, v10, 4, v253
    v_add_u32 v253, s64, v253
    v_lshlrev_b32 v254, 1, v5
    v_add_u32 v255, 98304, v14
    buffer_load_dwordx4 v[244:247], v253, s[40:43], 0 offen offset:0
    buffer_load_dwordx4 v[248:251], v253, s[40:43], 0 offen offset:32
    buffer_load_ushort v252, v254, s[48:51], 0 offen
    ds_read_b64_tr_b16 v[36:37], v196 offset:16384
    ds_read_b64_tr_b16 v[38:39], v196 offset:17408
    ds_read_b64_tr_b16 v[40:41], v197 offset:16384
    ds_read_b64_tr_b16 v[42:43], v197 offset:17408
    ds_read_b64_tr_b16 v[44:45], v196 offset:18432
    ds_read_b64_tr_b16 v[46:47], v196 offset:19456
    ds_read_b64_tr_b16 v[48:49], v197 offset:18432
    ds_read_b64_tr_b16 v[50:51], v197 offset:19456
    s_waitcnt lgkmcnt(4)
    ds_read_b64_tr_b16 v[52:53], v194 offset:16384
    ds_read_b64_tr_b16 v[54:55], v194 offset:17408
    ds_read_b64_tr_b16 v[56:57], v195 offset:16384
    ds_read_b64_tr_b16 v[58:59], v195 offset:17408
    ds_read_b64_tr_b16 v[60:61], v194 offset:18432
    ds_read_b64_tr_b16 v[62:63], v194 offset:19456
    ds_read_b64_tr_b16 v[64:65], v195 offset:18432
    ds_read_b64_tr_b16 v[66:67], v195 offset:19456
    s_waitcnt lgkmcnt(0)
    s_add_u32 s64, s75, 9
    s_sub_u32 s71, s64, 11
    s_cmp_ge_u32 s64, 11
    s_cselect_b32 s64, s71, s64
    s_lshl_b32 s64, s64, 2
    s_add_u32 s64, s64, s77
    s_lshl_b32 s64, s64, 17
    s_add_u32 m0, s89, 81920
    s_nop 0
    buffer_load_dwordx4 v193, s[36:39], s64 offen lds
    s_add_u32 m0, s89, 82944
    s_add_u32 s64, s64, 32768
    buffer_load_dwordx4 v193, s[36:39], s64 offen lds
    s_add_u32 m0, s89, 83968
    s_add_u32 s64, s64, 32768
    buffer_load_dwordx4 v193, s[36:39], s64 offen lds
    s_add_u32 m0, s89, 84992
    s_add_u32 s64, s64, 32768
    buffer_load_dwordx4 v193, s[36:39], s64 offen lds
    s_add_u32 s64, s75, 10
    s_sub_u32 s71, s64, 11
    s_cmp_ge_u32 s64, 11
    s_cselect_b32 s64, s71, s64
    s_lshl_b32 s64, s64, 2
    s_add_u32 s64, s64, s77
    s_lshl_b32 s64, s64, 17
    s_add_u32 m0, s89, 16384
    s_nop 0
    buffer_load_dwordx4 v193, s[36:39], s64 offen lds
    s_add_u32 m0, s89, 17408
    s_add_u32 s64, s64, 32768
    buffer_load_dwordx4 v193, s[36:39], s64 offen lds
    s_add_u32 m0, s89, 18432
    s_add_u32 s64, s64, 32768
    buffer_load_dwordx4 v193, s[36:39], s64 offen lds
    s_add_u32 m0, s89, 19456
    s_add_u32 s64, s64, 32768
    buffer_load_dwordx4 v193, s[36:39], s64 offen lds
    s_waitcnt vmcnt(31)
    ds_read_b64_tr_b16 v[212:213], v194 offset:32768
    ds_read_b64_tr_b16 v[214:215], v194 offset:33792
    ds_read_b64_tr_b16 v[216:217], v195 offset:32768
    ds_read_b64_tr_b16 v[218:219], v195 offset:33792
    ds_read_b64_tr_b16 v[220:221], v194 offset:34816
    ds_read_b64_tr_b16 v[222:223], v194 offset:35840
    ds_read_b64_tr_b16 v[224:225], v195 offset:34816
    ds_read_b64_tr_b16 v[226:227], v195 offset:35840
    s_waitcnt lgkmcnt(4)
    ds_read_b64_tr_b16 v[228:229], v194 offset:49152
    ds_read_b64_tr_b16 v[230:231], v194 offset:50176
    ds_read_b64_tr_b16 v[232:233], v195 offset:49152
    ds_read_b64_tr_b16 v[234:235], v195 offset:50176
    ds_read_b64_tr_b16 v[236:237], v194 offset:51200
    ds_read_b64_tr_b16 v[238:239], v194 offset:52224
    ds_read_b64_tr_b16 v[240:241], v195 offset:51200
    ds_read_b64_tr_b16 v[242:243], v195 offset:52224
    s_waitcnt lgkmcnt(0)
    s_add_u32 s64, s74, 0
    s_and_b32 s64, s64, 3
    s_lshl_b32 s64, s64, 2
    s_add_u32 s64, s64, s77
    s_lshl_b32 s64, s64, 15
    s_add_u32 m0, s89, 32768
    s_nop 0
    buffer_load_dwordx4 v192, s[52:55], s64 offen lds
    s_add_u32 m0, s89, 33792
    s_add_u32 s64, s64, 8192
    buffer_load_dwordx4 v192, s[52:55], s64 offen lds
    s_add_u32 m0, s89, 34816
    s_add_u32 s64, s64, 8192
    buffer_load_dwordx4 v192, s[52:55], s64 offen lds
    s_add_u32 m0, s89, 35840
    s_add_u32 s64, s64, 8192
    buffer_load_dwordx4 v192, s[52:55], s64 offen lds
    s_add_u32 s64, s74, 1
    s_and_b32 s64, s64, 3
    s_lshl_b32 s64, s64, 2
    s_add_u32 s64, s64, s77
    s_lshl_b32 s64, s64, 15
    s_add_u32 m0, s89, 49152
    s_nop 0
    buffer_load_dwordx4 v192, s[52:55], s64 offen lds
    s_add_u32 m0, s89, 50176
    s_add_u32 s64, s64, 8192
    buffer_load_dwordx4 v192, s[52:55], s64 offen lds
    s_add_u32 m0, s89, 51200
    s_add_u32 s64, s64, 8192
    buffer_load_dwordx4 v192, s[52:55], s64 offen lds
    s_add_u32 m0, s89, 52224
    s_add_u32 s64, s64, 8192
    buffer_load_dwordx4 v192, s[52:55], s64 offen lds
    s_mov_b32 s79, 3200000
lw_72:
    ds_read_b32 v5, v22 offset:32
    s_waitcnt lgkmcnt(0)
    v_readfirstlane_b32 s71, v5
    s_cmp_ge_u32 s71, 1
    s_cbranch_scc1 lwd_73
    s_sleep 1
    s_sub_u32 s79, s79, 1
    s_cmp_lg_u32 s79, 0
    s_cbranch_scc1 lw_72
lwd_73:
    s_add_u32 s64, s75, 0
    s_sub_u32 s71, s64, 11
    s_cmp_ge_u32 s64, 11
    s_cselect_b32 s64, s71, s64
    s_lshl_b32 s64, s64, 2
    s_add_u32 s64, s64, s77
    s_lshl_b32 s64, s64, 15
    s_add_u32 s64, s64, s70
    s_add_u32 s65, s64, 16384
    buffer_load_dwordx4 v[132:135], v14, s[44:47], s64 offen offset:0 sc1
    buffer_load_dwordx4 v[136:139], v14, s[44:47], s64 offen offset:1024 sc1
    buffer_load_dwordx4 v[140:143], v14, s[44:47], s65 offen offset:0 sc1
    buffer_load_dwordx4 v[144:147], v14, s[44:47], s65 offen offset:1024 sc1
    s_add_u32 s64, s75, 1
    s_sub_u32 s71, s64, 11
    s_cmp_ge_u32 s64, 11
    s_cselect_b32 s64, s71, s64
    s_lshl_b32 s64, s64, 2
    s_add_u32 s64, s64, s77
    s_lshl_b32 s64, s64, 15
    s_add_u32 s64, s64, s70
    s_add_u32 s65, s64, 16384
    buffer_load_dwordx4 v[148:151], v14, s[44:47], s64 offen offset:0 sc1
    buffer_load_dwordx4 v[152:155], v14, s[44:47], s64 offen offset:1024 sc1
    buffer_load_dwordx4 v[156:159], v14, s[44:47], s65 offen offset:0 sc1
    buffer_load_dwordx4 v[160:163], v14, s[44:47], s65 offen offset:1024 sc1
    s_add_u32 s64, s75, 2
    s_sub_u32 s71, s64, 11
    s_cmp_ge_u32 s64, 11
    s_cselect_b32 s64, s71, s64
    s_lshl_b32 s64, s64, 2
    s_add_u32 s64, s64, s77
    s_lshl_b32 s64, s64, 15
    s_add_u32 s64, s64, s70
    s_add_u32 s65, s64, 16384
    buffer_load_dwordx4 v[164:167], v14, s[44:47], s64 offen offset:0 sc1
    buffer_load_dwordx4 v[168:171], v14, s[44:47], s64 offen offset:1024 sc1
    buffer_load_dwordx4 v[172:175], v14, s[44:47], s65 offen offset:0 sc1
    buffer_load_dwordx4 v[176:179], v14, s[44:47], s65 offen offset:1024 sc1
    s_waitcnt lgkmcnt(0)
    s_waitcnt vmcnt(8)
    v_mfma_f32_32x32x16_bf16 v[68:83], v[132:135], v[36:39], 0
    v_mfma_f32_32x32x16_bf16 v[84:99], v[132:135], v[40:43], 0
    v_mfma_f32_32x32x16_bf16 v[100:115], v[136:139], v[36:39], 0
    v_mfma_f32_32x32x16_bf16 v[116:131], v[136:139], v[40:43], 0
    v_mfma_f32_32x32x16_bf16 v[68:83], v[140:143], v[44:47], v[68:83]
    v_mfma_f32_32x32x16_bf16 v[84:99], v[140:143], v[48:51], v[84:99]
    v_mfma_f32_32x32x16_bf16 v[100:115], v[144:147], v[44:47], v[100:115]
    v_mfma_f32_32x32x16_bf16 v[116:131], v[144:147], v[48:51], v[116:131]
    s_waitcnt lgkmcnt(0)
    s_waitcnt vmcnt(4)
    v_mfma_f32_32x32x16_bf16 v[68:83], v[148:151], v[52:55], v[68:83]
    s_add_u32 s64, s75, 3
    s_sub_u32 s71, s64, 11
    s_cmp_ge_u32 s64, 11
    s_cselect_b32 s64, s71, s64
    v_mfma_f32_32x32x16_bf16 v[84:99], v[148:151], v[56:59], v[84:99]
    s_lshl_b32 s64, s64, 2
    s_add_u32 s64, s64, s77
    s_lshl_b32 s64, s64, 15
    s_add_u32 s64, s64, s70
    v_mfma_f32_32x32x16_bf16 v[100:115], v[152:155], v[52:55], v[100:115]
    s_add_u32 s65, s64, 16384
    buffer_load_dwordx4 v[132:135], v14, s[44:47], s64 offen offset:0 sc1
    buffer_load_dwordx4 v[136:139], v14, s[44:47], s64 offen offset:1024 sc1
    buffer_load_dwordx4 v[140:143], v14, s[44:47], s65 offen offset:0 sc1
    v_mfma_f32_32x32x16_bf16 v[116:131], v[152:155], v[56:59], v[116:131]
    buffer_load_dwordx4 v[144:147], v14, s[44:47], s65 offen offset:1024 sc1
    v_mfma_f32_32x32x16_bf16 v[68:83], v[156:159], v[60:63], v[68:83]
    v_mfma_f32_32x32x16_bf16 v[84:99], v[156:159], v[64:67], v[84:99]
    v_mfma_f32_32x32x16_bf16 v[100:115], v[160:163], v[60:63], v[100:115]
    v_mfma_f32_32x32x16_bf16 v[116:131], v[160:163], v[64:67], v[116:131]
    s_waitcnt lgkmcnt(0)
    s_waitcnt vmcnt(4)
    v_mfma_f32_32x32x16_bf16 v[68:83], v[164:167], v[212:215], v[68:83]
    s_add_u32 s64, s75, 4
    s_sub_u32 s71, s64, 11
    s_cmp_ge_u32 s64, 11
    s_cselect_b32 s64, s71, s64
    v_mfma_f32_32x32x16_bf16 v[84:99], v[164:167], v[216:219], v[84:99]
    s_lshl_b32 s64, s64, 2
    s_add_u32 s64, s64, s77
    s_lshl_b32 s64, s64, 15
    s_add_u32 s64, s64, s70
    v_mfma_f32_32x32x16_bf16 v[100:115], v[168:171], v[212:215], v[100:115]
    s_add_u32 s65, s64, 16384
    buffer_load_dwordx4 v[148:151], v14, s[44:47], s64 offen offset:0 sc1
    buffer_load_dwordx4 v[152:155], v14, s[44:47], s64 offen offset:1024 sc1
    buffer_load_dwordx4 v[156:159], v14, s[44:47], s65 offen offset:0 sc1
    v_mfma_f32_32x32x16_bf16 v[116:131], v[168:171], v[216:219], v[116:131]
    buffer_load_dwordx4 v[160:163], v14, s[44:47], s65 offen offset:1024 sc1
    v_mfma_f32_32x32x16_bf16 v[68:83], v[172:175], v[220:223], v[68:83]
    v_mfma_f32_32x32x16_bf16 v[84:99], v[172:175], v[224:227], v[84:99]
    v_mfma_f32_32x32x16_bf16 v[100:115], v[176:179], v[220:223], v[100:115]
    v_mfma_f32_32x32x16_bf16 v[116:131], v[176:179], v[224:227], v[116:131]
    s_waitcnt lgkmcnt(0)
    s_waitcnt vmcnt(4)
    v_mfma_f32_32x32x16_bf16 v[68:83], v[132:135], v[228:231], v[68:83]
    ds_read_b64_tr_b16 v[36:37], v196 offset:0
    ds_read_b64_tr_b16 v[38:39], v196 offset:1024
    ds_read_b64_tr_b16 v[40:41], v197 offset:0
    ds_read_b64_tr_b16 v[42:43], v197 offset:1024
    ds_read_b64_tr_b16 v[44:45], v196 offset:2048
    v_mfma_f32_32x32x16_bf16 v[84:99], v[132:135], v[232:235], v[84:99]
    ds_read_b64_tr_b16 v[46:47], v196 offset:3072
    ds_read_b64_tr_b16 v[48:49], v197 offset:2048
    ds_read_b64_tr_b16 v[50:51], v197 offset:3072
    s_add_u32 s64, s75, 5
    s_sub_u32 s71, s64, 11
    v_mfma_f32_32x32x16_bf16 v[100:115], v[136:139], v[228:231], v[100:115]
    s_cmp_ge_u32 s64, 11
    s_cselect_b32 s64, s71, s64
    s_lshl_b32 s64, s64, 2
    s_add_u32 s64, s64, s77
    s_lshl_b32 s64, s64, 15
    v_mfma_f32_32x32x16_bf16 v[116:131], v[136:139], v[232:235], v[116:131]
    s_add_u32 s64, s64, s70
    s_add_u32 s65, s64, 16384
    buffer_load_dwordx4 v[164:167], v14, s[44:47], s64 offen offset:0 sc1
    buffer_load_dwordx4 v[168:171], v14, s[44:47], s64 offen offset:1024 sc1
    buffer_load_dwordx4 v[172:175], v14, s[44:47], s65 offen offset:0 sc1
    v_mfma_f32_32x32x16_bf16 v[68:83], v[140:143], v[236:239], v[68:83]
    buffer_load_dwordx4 v[176:179], v14, s[44:47], s65 offen offset:1024 sc1
    s_add_u32 s64, s75, 6
    s_sub_u32 s71, s64, 11
    s_cmp_ge_u32 s64, 11
    s_cselect_b32 s64, s71, s64
    v_mfma_f32_32x32x16_bf16 v[84:99], v[140:143], v[240:243], v[84:99]
    s_lshl_b32 s64, s64, 2
    s_add_u32 s64, s64, s77
    s_lshl_b32 s64, s64, 15
    s_add_u32 s64, s64, s70
    s_add_u32 s65, s64, 16384
    v_mfma_f32_32x32x16_bf16 v[100:115], v[144:147], v[236:239], v[100:115]
    buffer_load_dwordx4 v[212:215], v14, s[44:47], s64 offen offset:0 sc1
    buffer_load_dwordx4 v[216:219], v14, s[44:47], s64 offen offset:1024 sc1
    buffer_load_dwordx4 v[220:223], v14, s[44:47], s65 offen offset:0 sc1
    buffer_load_dwordx4 v[224:227], v14, s[44:47], s65 offen offset:1024 sc1
    v_mfma_f32_32x32x16_bf16 v[116:131], v[144:147], v[240:243], v[116:131]
    s_waitcnt lgkmcnt(0)
    s_waitcnt vmcnt(8)
    v_mfma_f32_32x32x16_bf16 v[68:83], v[148:151], v[36:39], v[68:83]
    ds_read_b64_tr_b16 v[52:53], v194 offset:0
    ds_read_b64_tr_b16 v[54:55], v194 offset:1024
    ds_read_b64_tr_b16 v[56:57], v195 offset:0
    ds_read_b64_tr_b16 v[58:59], v195 offset:1024
    ds_read_b64_tr_b16 v[60:61], v194 offset:2048
    ds_read_b64_tr_b16 v[62:63], v194 offset:3072
    ds_read_b64_tr_b16 v[64:65], v195 offset:2048
    v_mfma_f32_32x32x16_bf16 v[84:99], v[148:151], v[40:43], v[84:99]
    ds_read_b64_tr_b16 v[66:67], v195 offset:3072
    s_add_u32 s64, s75, 7
    s_sub_u32 s71, s64, 11
    s_cmp_ge_u32 s64, 11
    s_cselect_b32 s64, s71, s64
    s_lshl_b32 s64, s64, 2
    s_add_u32 s64, s64, s77
    v_mfma_f32_32x32x16_bf16 v[100:115], v[152:155], v[36:39], v[100:115]
    s_lshl_b32 s64, s64, 15
    s_add_u32 s64, s64, s70
    s_add_u32 s65, s64, 16384
    buffer_load_dwordx4 v[132:135], v14, s[44:47], s64 offen offset:0 sc1
    buffer_load_dwordx4 v[136:139], v14, s[44:47], s64 offen offset:1024 sc1
    buffer_load_dwordx4 v[140:143], v14, s[44:47], s65 offen offset:0 sc1
    buffer_load_dwordx4 v[144:147], v14, s[44:47], s65 offen offset:1024 sc1
    v_mfma_f32_32x32x16_bf16 v[116:131], v[152:155], v[40:43], v[116:131]
    s_add_u32 s64, s75, 8
    s_sub_u32 s71, s64, 11
    s_cmp_ge_u32 s64, 11
    s_cselect_b32 s64, s71, s64
    s_lshl_b32 s64, s64, 2
    s_add_u32 s64, s64, s77
    s_lshl_b32 s64, s64, 15
    v_mfma_f32_32x32x16_bf16 v[68:83], v[156:159], v[44:47], v[68:83]
    s_add_u32 s64, s64, s70
    s_add_u32 s65, s64, 16384
    buffer_load_dwordx4 v[228:231], v14, s[44:47], s64 offen offset:0 sc1
    buffer_load_dwordx4 v[232:235], v14, s[44:47], s64 offen offset:1024 sc1
    buffer_load_dwordx4 v[236:239], v14, s[44:47], s65 offen offset:0 sc1
    buffer_load_dwordx4 v[240:243], v14, s[44:47], s65 offen offset:1024 sc1
    s_add_u32 s64, s74, 2
    v_mfma_f32_32x32x16_bf16 v[84:99], v[156:159], v[48:51], v[84:99]
    s_and_b32 s64, s64, 3
    s_lshl_b32 s64, s64, 2
    s_add_u32 s64, s64, s77
    s_lshl_b32 s64, s64, 15
    s_add_u32 m0, s89, 65536
    s_nop 0
    buffer_load_dwordx4 v192, s[52:55], s64 offen lds
    s_add_u32 m0, s89, 66560
    v_mfma_f32_32x32x16_bf16 v[100:115], v[160:163], v[44:47], v[100:115]
    s_add_u32 s64, s64, 8192
    buffer_load_dwordx4 v192, s[52:55], s64 offen lds
    s_add_u32 m0, s89, 67584
    s_add_u32 s64, s64, 8192
    buffer_load_dwordx4 v192, s[52:55], s64 offen lds
    s_add_u32 m0, s89, 68608
    s_add_u32 s64, s64, 8192
    v_mfma_f32_32x32x16_bf16 v[116:131], v[160:163], v[48:51], v[116:131]
    buffer_load_dwordx4 v192, s[52:55], s64 offen lds
    s_waitcnt lgkmcnt(0)
    s_waitcnt vmcnt(16)
    v_mfma_f32_32x32x16_bf16 v[68:83], v[164:167], v[52:55], v[68:83]
    ds_read_b64_tr_b16 v[36:37], v196 offset:32768
    ds_read_b64_tr_b16 v[38:39], v196 offset:33792
    ds_read_b64_tr_b16 v[40:41], v197 offset:32768
    ds_read_b64_tr_b16 v[42:43], v197 offset:33792
    ds_read_b64_tr_b16 v[44:45], v196 offset:34816
    v_mfma_f32_32x32x16_bf16 v[84:99], v[164:167], v[56:59], v[84:99]
    ds_read_b64_tr_b16 v[46:47], v196 offset:35840
    ds_read_b64_tr_b16 v[48:49], v197 offset:34816
    ds_read_b64_tr_b16 v[50:51], v197 offset:35840
    s_add_u32 s64, s75, 9
    s_sub_u32 s71, s64, 11
    v_mfma_f32_32x32x16_bf16 v[100:115], v[168:171], v[52:55], v[100:115]
    s_cmp_ge_u32 s64, 11
    s_cselect_b32 s64, s71, s64
    s_lshl_b32 s64, s64, 2
    s_add_u32 s64, s64, s77
    s_lshl_b32 s64, s64, 15
    v_mfma_f32_32x32x16_bf16 v[116:131], v[168:171], v[56:59], v[116:131]
    s_add_u32 s64, s64, s70
    s_add_u32 s65, s64, 16384
    buffer_load_dwordx4 v[148:151], v14, s[44:47], s64 offen offset:0 sc1
    buffer_load_dwordx4 v[152:155], v14, s[44:47], s64 offen offset:1024 sc1
    buffer_load_dwordx4 v[156:159], v14, s[44:47], s65 offen offset:0 sc1
    v_mfma_f32_32x32x16_bf16 v[68:83], v[172:175], v[60:63], v[68:83]
    buffer_load_dwordx4 v[160:163], v14, s[44:47], s65 offen offset:1024 sc1
    s_add_u32 s64, s74, 3
    s_and_b32 s64, s64, 3
    s_lshl_b32 s64, s64, 2
    s_add_u32 s64, s64, s77
    v_mfma_f32_32x32x16_bf16 v[84:99], v[172:175], v[64:67], v[84:99]
    s_lshl_b32 s64, s64, 15
    s_add_u32 m0, s89, 0
    s_nop 0
    buffer_load_dwordx4 v192, s[52:55], s64 offen lds
    s_add_u32 m0, s89, 1024
    s_add_u32 s64, s64, 8192
    v_mfma_f32_32x32x16_bf16 v[100:115], v[176:179], v[60:63], v[100:115]
    buffer_load_dwordx4 v192, s[52:55], s64 offen lds
    s_add_u32 m0, s89, 2048
    s_add_u32 s64, s64, 8192
    buffer_load_dwordx4 v192, s[52:55], s64 offen lds
    s_add_u32 m0, s89, 3072
    v_mfma_f32_32x32x16_bf16 v[116:131], v[176:179], v[64:67], v[116:131]
    s_add_u32 s64, s64, 8192
    buffer_load_dwordx4 v192, s[52:55], s64 offen lds
    s_waitcnt lgkmcnt(0)
    s_waitcnt vmcnt(20)
    v_mfma_f32_32x32x16_bf16 v[68:83], v[212:215], v[36:39], v[68:83]
    ds_read_b64_tr_b16 v[52:53], v196 offset:49152
    ds_read_b64_tr_b16 v[54:55], v196 offset:50176
    ds_read_b64_tr_b16 v[56:57], v197 offset:49152
    ds_read_b64_tr_b16 v[58:59], v197 offset:50176
    v_mfma_f32_32x32x16_bf16 v[84:99], v[212:215], v[40:43], v[84:99]
    ds_read_b64_tr_b16 v[60:61], v196 offset:51200
    ds_read_b64_tr_b16 v[62:63], v196 offset:52224
    ds_read_b64_tr_b16 v[64:65], v197 offset:51200
    ds_read_b64_tr_b16 v[66:67], v197 offset:52224
    v_mfma_f32_32x32x16_bf16 v[100:115], v[216:219], v[36:39], v[100:115]
    s_add_u32 s64, s75, 10
    s_sub_u32 s71, s64, 11
    s_cmp_ge_u32 s64, 11
    s_cselect_b32 s64, s71, s64
    v_mfma_f32_32x32x16_bf16 v[116:131], v[216:219], v[40:43], v[116:131]
    s_lshl_b32 s64, s64, 2
    s_add_u32 s64, s64, s77
    s_lshl_b32 s64, s64, 15
    s_add_u32 s64, s64, s70
    v_mfma_f32_32x32x16_bf16 v[68:83], v[220:223], v[44:47], v[68:83]
    s_add_u32 s65, s64, 16384
    buffer_load_dwordx4 v[164:167], v14, s[44:47], s64 offen offset:0 sc1
    buffer_load_dwordx4 v[168:171], v14, s[44:47], s64 offen offset:1024 sc1
    buffer_load_dwordx4 v[172:175], v14, s[44:47], s65 offen offset:0 sc1
    v_mfma_f32_32x32x16_bf16 v[84:99], v[220:223], v[48:51], v[84:99]
    buffer_load_dwordx4 v[176:179], v14, s[44:47], s65 offen offset:1024 sc1
    v_mfma_f32_32x32x16_bf16 v[100:115], v[224:227], v[44:47], v[100:115]
    v_mfma_f32_32x32x16_bf16 v[116:131], v[224:227], v[48:51], v[116:131]
    s_waitcnt lgkmcnt(0)
    s_waitcnt vmcnt(20)
    v_mfma_f32_32x32x16_bf16 v[68:83], v[132:135], v[52:55], v[68:83]
    v_mfma_f32_32x32x16_bf16 v[84:99], v[132:135], v[56:59], v[84:99]
    v_mfma_f32_32x32x16_bf16 v[100:115], v[136:139], v[52:55], v[100:115]
    v_mfma_f32_32x32x16_bf16 v[116:131], v[136:139], v[56:59], v[116:131]
    v_mfma_f32_32x32x16_bf16 v[68:83], v[140:143], v[60:63], v[68:83]
    v_mfma_f32_32x32x16_bf16 v[84:99], v[140:143], v[64:67], v[84:99]
    v_mfma_f32_32x32x16_bf16 v[100:115], v[144:147], v[60:63], v[100:115]
    v_mfma_f32_32x32x16_bf16 v[116:131], v[144:147], v[64:67], v[116:131]
    ds_read_b64_tr_b16 v[36:37], v198 offset:0
    ds_read_b64_tr_b16 v[38:39], v198 offset:1024
    ds_read_b64_tr_b16 v[40:41], v199 offset:0
    ds_read_b64_tr_b16 v[42:43], v199 offset:1024
    ds_read_b64_tr_b16 v[44:45], v198 offset:2048
    ds_read_b64_tr_b16 v[46:47], v198 offset:3072
    ds_read_b64_tr_b16 v[48:49], v199 offset:2048
    ds_read_b64_tr_b16 v[50:51], v199 offset:3072
    s_mov_b32 s79, 3200000
lw_74:
    ds_read_b32 v5, v22 offset:28
    s_waitcnt lgkmcnt(0)
    v_readfirstlane_b32 s71, v5
    s_cmp_ge_u32 s71, 1
    s_cbranch_scc1 lwd_75
    s_sleep 1
    s_sub_u32 s79, s79, 1
    s_cmp_lg_u32 s79, 0
    s_cbranch_scc1 lw_74
lwd_75:
    s_add_u32 s64, s74, 0
    s_and_b32 s64, s64, 3
    s_lshl_b32 s64, s64, 2
    s_add_u32 s64, s64, s77
    s_lshl_b32 s64, s64, 17
    s_add_u32 s64, s64, s69
    s_add_u32 s65, s64, 65536
    buffer_load_dwordx4 v[212:215], v14, s[56:59], s64 offen offset:0 sc1
    buffer_load_dwordx4 v[216:219], v14, s[56:59], s64 offen offset:1024 sc1
    buffer_load_dwordx4 v[220:223], v14, s[56:59], s65 offen offset:0 sc1
    buffer_load_dwordx4 v[224:227], v14, s[56:59], s65 offen offset:1024 sc1
    s_waitcnt lgkmcnt(0)
    s_waitcnt vmcnt(20)
    v_mfma_f32_32x32x16_bf16 v[68:83], v[228:231], v[36:39], v[68:83]
    ds_read_b64_tr_b16 v[52:53], v196 offset:16384
    ds_read_b64_tr_b16 v[54:55], v196 offset:17408
    ds_read_b64_tr_b16 v[56:57], v197 offset:16384
    ds_read_b64_tr_b16 v[58:59], v197 offset:17408
    v_mfma_f32_32x32x16_bf16 v[84:99], v[228:231], v[40:43], v[84:99]
    ds_read_b64_tr_b16 v[60:61], v196 offset:18432
    ds_read_b64_tr_b16 v[62:63], v196 offset:19456
    ds_read_b64_tr_b16 v[64:65], v197 offset:18432
    ds_read_b64_tr_b16 v[66:67], v197 offset:19456
    v_mfma_f32_32x32x16_bf16 v[100:115], v[232:235], v[36:39], v[100:115]
    s_add_u32 s64, s74, 1
    s_and_b32 s64, s64, 3
    s_lshl_b32 s64, s64, 2
    s_add_u32 s64, s64, s77
    v_mfma_f32_32x32x16_bf16 v[116:131], v[232:235], v[40:43], v[116:131]
    s_lshl_b32 s64, s64, 17
    s_add_u32 s64, s64, s69
    s_add_u32 s65, s64, 65536
    buffer_load_dwordx4 v[132:135], v14, s[56:59], s64 offen offset:0 sc1
    v_mfma_f32_32x32x16_bf16 v[68:83], v[236:239], v[44:47], v[68:83]
    buffer_load_dwordx4 v[136:139], v14, s[56:59], s64 offen offset:1024 sc1
    buffer_load_dwordx4 v[140:143], v14, s[56:59], s65 offen offset:0 sc1
    buffer_load_dwordx4 v[144:147], v14, s[56:59], s65 offen offset:1024 sc1
    v_mfma_f32_32x32x16_bf16 v[84:99], v[236:239], v[48:51], v[84:99]
    v_mfma_f32_32x32x16_bf16 v[100:115], v[240:243], v[44:47], v[100:115]
    v_mfma_f32_32x32x16_bf16 v[116:131], v[240:243], v[48:51], v[116:131]
    s_waitcnt lgkmcnt(0)
    s_waitcnt lgkmcnt(0)
    s_mov_b64 exec, 1
    ds_add_u32 v22, v23 offset:52
    s_mov_b64 exec, -1
    s_waitcnt vmcnt(16)
    v_mfma_f32_32x32x16_bf16 v[68:83], v[148:151], v[52:55], v[68:83]
    ds_read_b64_tr_b16 v[36:37], v194 offset:16384
    ds_read_b64_tr_b16 v[38:39], v194 offset:17408
    ds_read_b64_tr_b16 v[40:41], v195 offset:16384
    ds_read_b64_tr_b16 v[42:43], v195 offset:17408
    v_mfma_f32_32x32x16_bf16 v[84:99], v[148:151], v[56:59], v[84:99]
    ds_read_b64_tr_b16 v[44:45], v194 offset:18432
    ds_read_b64_tr_b16 v[46:47], v194 offset:19456
    ds_read_b64_tr_b16 v[48:49], v195 offset:18432
    ds_read_b64_tr_b16 v[50:51], v195 offset:19456
    v_mfma_f32_32x32x16_bf16 v[100:115], v[152:155], v[52:55], v[100:115]
    s_add_u32 s64, s74, 2
    s_and_b32 s64, s64, 3
    s_lshl_b32 s64, s64, 2
    s_add_u32 s64, s64, s77
    v_mfma_f32_32x32x16_bf16 v[116:131], v[152:155], v[56:59], v[116:131]
    s_lshl_b32 s64, s64, 17
    s_add_u32 s64, s64, s69
    s_add_u32 s65, s64, 65536
    buffer_load_dwordx4 v[228:231], v14, s[56:59], s64 offen offset:0 sc1
    v_mfma_f32_32x32x16_bf16 v[68:83], v[156:159], v[60:63], v[68:83]
    buffer_load_dwordx4 v[232:235], v14, s[56:59], s64 offen offset:1024 sc1
    buffer_load_dwordx4 v[236:239], v14, s[56:59], s65 offen offset:0 sc1
    buffer_load_dwordx4 v[240:243], v14, s[56:59], s65 offen offset:1024 sc1
    v_mfma_f32_32x32x16_bf16 v[84:99], v[156:159], v[64:67], v[84:99]
    v_mfma_f32_32x32x16_bf16 v[100:115], v[160:163], v[60:63], v[100:115]
    v_mfma_f32_32x32x16_bf16 v[116:131], v[160:163], v[64:67], v[116:131]
    s_waitcnt lgkmcnt(0)
    s_waitcnt vmcnt(12)
    v_mfma_f32_32x32x16_bf16 v[68:83], v[164:167], v[36:39], v[68:83]
    ds_read_b64_tr_b16 v[52:53], v194 offset:32768
    ds_read_b64_tr_b16 v[54:55], v194 offset:33792
    ds_read_b64_tr_b16 v[56:57], v195 offset:32768
    ds_read_b64_tr_b16 v[58:59], v195 offset:33792
    v_mfma_f32_32x32x16_bf16 v[84:99], v[164:167], v[40:43], v[84:99]
    ds_read_b64_tr_b16 v[60:61], v194 offset:34816
    ds_read_b64_tr_b16 v[62:63], v194 offset:35840
    ds_read_b64_tr_b16 v[64:65], v195 offset:34816
    ds_read_b64_tr_b16 v[66:67], v195 offset:35840
    v_mfma_f32_32x32x16_bf16 v[100:115], v[168:171], v[36:39], v[100:115]
    s_add_u32 s64, s74, 3
    s_and_b32 s64, s64, 3
    s_lshl_b32 s64, s64, 2
    s_add_u32 s64, s64, s77
    v_mfma_f32_32x32x16_bf16 v[116:131], v[168:171], v[40:43], v[116:131]
    s_lshl_b32 s64, s64, 17
    s_add_u32 s64, s64, s69
    s_add_u32 s65, s64, 65536
    buffer_load_dwordx4 v[148:151], v14, s[56:59], s64 offen offset:0 sc1
    v_mfma_f32_32x32x16_bf16 v[68:83], v[172:175], v[44:47], v[68:83]
    buffer_load_dwordx4 v[152:155], v14, s[56:59], s64 offen offset:1024 sc1
    buffer_load_dwordx4 v[156:159], v14, s[56:59], s65 offen offset:0 sc1
    buffer_load_dwordx4 v[160:163], v14, s[56:59], s65 offen offset:1024 sc1
    v_mfma_f32_32x32x16_bf16 v[84:99], v[172:175], v[48:51], v[84:99]
    v_mfma_f32_32x32x16_bf16 v[100:115], v[176:179], v[44:47], v[100:115]
    v_mfma_f32_32x32x16_bf16 v[116:131], v[176:179], v[48:51], v[116:131]
    s_waitcnt lgkmcnt(0)
    s_waitcnt vmcnt(12)
    v_mfma_f32_32x32x16_bf16 v[68:83], v[52:55], v[212:215], v[68:83]
    ds_read_b64_tr_b16 v[36:37], v194 offset:49152
    ds_read_b64_tr_b16 v[38:39], v194 offset:50176
    ds_read_b64_tr_b16 v[40:41], v195 offset:49152
    ds_read_b64_tr_b16 v[42:43], v195 offset:50176
    v_mfma_f32_32x32x16_bf16 v[84:99], v[52:55], v[216:219], v[84:99]
    ds_read_b64_tr_b16 v[44:45], v194 offset:51200
    ds_read_b64_tr_b16 v[46:47], v194 offset:52224
    ds_read_b64_tr_b16 v[48:49], v195 offset:51200
    ds_read_b64_tr_b16 v[50:51], v195 offset:52224
    v_mfma_f32_32x32x16_bf16 v[100:115], v[56:59], v[212:215], v[100:115]
    v_mfma_f32_32x32x16_bf16 v[116:131], v[56:59], v[216:219], v[116:131]
    v_mfma_f32_32x32x16_bf16 v[68:83], v[60:63], v[220:223], v[68:83]
    v_mfma_f32_32x32x16_bf16 v[84:99], v[60:63], v[224:227], v[84:99]
    v_mfma_f32_32x32x16_bf16 v[100:115], v[64:67], v[220:223], v[100:115]
    v_mfma_f32_32x32x16_bf16 v[116:131], v[64:67], v[224:227], v[116:131]
    s_waitcnt lgkmcnt(0)
    s_waitcnt vmcnt(8)
    v_mfma_f32_32x32x16_bf16 v[68:83], v[36:39], v[132:135], v[68:83]
    ds_read_b64_tr_b16 v[52:53], v196 offset:0
    ds_read_b64_tr_b16 v[54:55], v196 offset:1024
    ds_read_b64_tr_b16 v[56:57], v197 offset:0
    ds_read_b64_tr_b16 v[58:59], v197 offset:1024
    v_mfma_f32_32x32x16_bf16 v[84:99], v[36:39], v[136:139], v[84:99]
    ds_read_b64_tr_b16 v[60:61], v196 offset:2048
    ds_read_b64_tr_b16 v[62:63], v196 offset:3072
    ds_read_b64_tr_b16 v[64:65], v197 offset:2048
    ds_read_b64_tr_b16 v[66:67], v197 offset:3072
    v_mfma_f32_32x32x16_bf16 v[100:115], v[40:43], v[132:135], v[100:115]
    v_mfma_f32_32x32x16_bf16 v[116:131], v[40:43], v[136:139], v[116:131]
    v_mfma_f32_32x32x16_bf16 v[68:83], v[44:47], v[140:143], v[68:83]
    v_mfma_f32_32x32x16_bf16 v[84:99], v[44:47], v[144:147], v[84:99]
    v_mfma_f32_32x32x16_bf16 v[100:115], v[48:51], v[140:143], v[100:115]
    v_mfma_f32_32x32x16_bf16 v[116:131], v[48:51], v[144:147], v[116:131]
    s_waitcnt lgkmcnt(0)
    s_waitcnt vmcnt(4)
    v_mfma_f32_32x32x16_bf16 v[68:83], v[52:55], v[228:231], v[68:83]
    ds_read_b64_tr_b16 v[36:37], v194 offset:0
    ds_read_b64_tr_b16 v[38:39], v194 offset:1024
    ds_read_b64_tr_b16 v[40:41], v195 offset:0
    ds_read_b64_tr_b16 v[42:43], v195 offset:1024
    v_mfma_f32_32x32x16_bf16 v[84:99], v[52:55], v[232:235], v[84:99]
    ds_read_b64_tr_b16 v[44:45], v194 offset:2048
    ds_read_b64_tr_b16 v[46:47], v194 offset:3072
    ds_read_b64_tr_b16 v[48:49], v195 offset:2048
    ds_read_b64_tr_b16 v[50:51], v195 offset:3072
    v_mfma_f32_32x32x16_bf16 v[100:115], v[56:59], v[228:231], v[100:115]
    v_mfma_f32_32x32x16_bf16 v[116:131], v[56:59], v[232:235], v[116:131]
    v_mfma_f32_32x32x16_bf16 v[68:83], v[60:63], v[236:239], v[68:83]
    v_mfma_f32_32x32x16_bf16 v[84:99], v[60:63], v[240:243], v[84:99]
    v_mfma_f32_32x32x16_bf16 v[100:115], v[64:67], v[236:239], v[100:115]
    v_mfma_f32_32x32x16_bf16 v[116:131], v[64:67], v[240:243], v[116:131]
    s_waitcnt lgkmcnt(0)
    s_waitcnt vmcnt(0)
    v_mfma_f32_32x32x16_bf16 v[68:83], v[36:39], v[148:151], v[68:83]
    v_mfma_f32_32x32x16_bf16 v[84:99], v[36:39], v[152:155], v[84:99]
    v_mfma_f32_32x32x16_bf16 v[100:115], v[40:43], v[148:151], v[100:115]
    v_mfma_f32_32x32x16_bf16 v[116:131], v[40:43], v[152:155], v[116:131]
    v_mfma_f32_32x32x16_bf16 v[68:83], v[44:47], v[156:159], v[68:83]
    v_mfma_f32_32x32x16_bf16 v[84:99], v[44:47], v[160:163], v[84:99]
    v_mfma_f32_32x32x16_bf16 v[100:115], v[48:51], v[156:159], v[100:115]
    v_mfma_f32_32x32x16_bf16 v[116:131], v[48:51], v[160:163], v[116:131]
    s_mov_b32 s79, 3200000
lw_76:
    ds_read_b32 v5, v22 offset:52
    s_waitcnt lgkmcnt(0)
    v_readfirstlane_b32 s71, v5
    s_cmp_ge_u32 s71, 4
    s_cbranch_scc1 lwd_77
    s_sub_u32 s79, s79, 1
    s_cmp_lg_u32 s79, 0
    s_cbranch_scc1 lw_76
lwd_77:
    s_mov_b32 s52, s22
    s_mov_b32 s53, s23
    s_mov_b32 s54, 0x200000
    s_mov_b32 s55, 0x20000
    s_cmp_eq_u32 s77, 1
    s_cbranch_scc1 fr_79
    s_cmp_eq_u32 s77, 2
    s_cbranch_scc1 fr_80
    s_cmp_eq_u32 s77, 3
    s_cbranch_scc1 fr_81
fr_78:
    ds_write_b128 v255, v[84:87] offset:36864
    ds_write_b128 v255, v[88:91] offset:37888
    ds_write_b128 v255, v[92:95] offset:38912
    ds_write_b128 v255, v[96:99] offset:39936
    ds_write_b128 v255, v[100:103] offset:24576
    ds_write_b128 v255, v[104:107] offset:25600
    ds_write_b128 v255, v[108:111] offset:26624
    ds_write_b128 v255, v[112:115] offset:27648
    ds_write_b128 v255, v[116:119] offset:12288
    ds_write_b128 v255, v[120:123] offset:13312
    ds_write_b128 v255, v[124:127] offset:14336
    ds_write_b128 v255, v[128:131] offset:15360
    v_pk_add_f32 v[164:165], v[68:69], v[16:17]
    v_pk_add_f32 v[166:167], v[70:71], v[16:17]
    v_pk_add_f32 v[168:169], v[72:73], v[16:17]
    v_pk_add_f32 v[170:171], v[74:75], v[16:17]
    v_pk_add_f32 v[172:173], v[76:77], v[16:17]
    v_pk_add_f32 v[174:175], v[78:79], v[16:17]
    v_pk_add_f32 v[176:177], v[80:81], v[16:17]
    v_pk_add_f32 v[178:179], v[82:83], v[16:17]
    s_branch frd_82
fr_79:
    ds_write_b128 v255, v[68:71] offset:0
    ds_write_b128 v255, v[72:75] offset:1024
    ds_write_b128 v255, v[76:79] offset:2048
    ds_write_b128 v255, v[80:83] offset:3072
    ds_write_b128 v255, v[100:103] offset:40960
    ds_write_b128 v255, v[104:107] offset:41984
    ds_write_b128 v255, v[108:111] offset:43008
    ds_write_b128 v255, v[112:115] offset:44032
    ds_write_b128 v255, v[116:119] offset:28672
    ds_write_b128 v255, v[120:123] offset:29696
    ds_write_b128 v255, v[124:127] offset:30720
    ds_write_b128 v255, v[128:131] offset:31744
    v_pk_add_f32 v[164:165], v[84:85], v[16:17]
    v_pk_add_f32 v[166:167], v[86:87], v[16:17]
    v_pk_add_f32 v[168:169], v[88:89], v[16:17]
    v_pk_add_f32 v[170:171], v[90:91], v[16:17]
    v_pk_add_f32 v[172:173], v[92:93], v[16:17]
    v_pk_add_f32 v[174:175], v[94:95], v[16:17]
    v_pk_add_f32 v[176:177], v[96:97], v[16:17]
    v_pk_add_f32 v[178:179], v[98:99], v[16:17]
    s_branch frd_82
fr_80:
    ds_write_b128 v255, v[68:71] offset:16384
    ds_write_b128 v255, v[72:75] offset:17408
    ds_write_b128 v255, v[76:79] offset:18432
    ds_write_b128 v255, v[80:83] offset:19456
    ds_write_b128 v255, v[84:87] offset:4096
    ds_write_b128 v255, v[88:91] offset:5120
    ds_write_b128 v255, v[92:95] offset:6144
    ds_write_b128 v255, v[96:99] offset:7168
    ds_write_b128 v255, v[116:119] offset:45056
    ds_write_b128 v255, v[120:123] offset:46080
    ds_write_b128 v255, v[124:127] offset:47104
    ds_write_b128 v255, v[128:131] offset:48128
    v_pk_add_f32 v[164:165], v[100:101], v[16:17]
    v_pk_add_f32 v[166:167], v[102:103], v[16:17]
    v_pk_add_f32 v[168:169], v[104:105], v[16:17]
    v_pk_add_f32 v[170:171], v[106:107], v[16:17]
    v_pk_add_f32 v[172:173], v[108:109], v[16:17]
    v_pk_add_f32 v[174:175], v[110:111], v[16:17]
    v_pk_add_f32 v[176:177], v[112:113], v[16:17]
    v_pk_add_f32 v[178:179], v[114:115], v[16:17]
    s_branch frd_82
fr_81:
    ds_write_b128 v255, v[68:71] offset:32768
    ds_write_b128 v255, v[72:75] offset:33792
    ds_write_b128 v255, v[76:79] offset:34816
    ds_write_b128 v255, v[80:83] offset:35840
    ds_write_b128 v255, v[84:87] offset:20480
    ds_write_b128 v255, v[88:91] offset:21504
    ds_write_b128 v255, v[92:95] offset:22528
    ds_write_b128 v255, v[96:99] offset:23552
    ds_write_b128 v255, v[100:103] offset:8192
    ds_write_b128 v255, v[104:107] offset:9216
    ds_write_b128 v255, v[108:111] offset:10240
    ds_write_b128 v255, v[112:115] offset:11264
    v_pk_add_f32 v[164:165], v[116:117], v[16:17]
    v_pk_add_f32 v[166:167], v[118:119], v[16:17]
    v_pk_add_f32 v[168:169], v[120:121], v[16:17]
    v_pk_add_f32 v[170:171], v[122:123], v[16:17]
    v_pk_add_f32 v[172:173], v[124:125], v[16:17]
    v_pk_add_f32 v[174:175], v[126:127], v[16:17]
    v_pk_add_f32 v[176:177], v[128:129], v[16:17]
    v_pk_add_f32 v[178:179], v[130:131], v[16:17]
frd_82:
    s_waitcnt lgkmcnt(0)
    s_mov_b64 exec, 1
    ds_add_u32 v22, v23 offset:16
    s_mov_b64 exec, -1
    v_add_u32 v255, s89, v255
    v_permlane32_swap_b32 v244, v246
    v_permlane32_swap_b32 v245, v247
    v_permlane32_swap_b32 v248, v250
    v_permlane32_swap_b32 v249, v251
    v_lshlrev_b32 v212, 16, v244
    v_and_b32 v213, 0xffff0000, v244
    v_lshlrev_b32 v214, 16, v245
    v_and_b32 v215, 0xffff0000, v245
    v_lshlrev_b32 v216, 16, v246
    v_and_b32 v217, 0xffff0000, v246
    v_lshlrev_b32 v218, 16, v247
    v_and_b32 v219, 0xffff0000, v247
    v_lshlrev_b32 v220, 16, v248
    v_and_b32 v221, 0xffff0000, v248
    v_lshlrev_b32 v222, 16, v249
    v_and_b32 v223, 0xffff0000, v249
    v_lshlrev_b32 v224, 16, v250
    v_and_b32 v225, 0xffff0000, v250
    v_lshlrev_b32 v226, 16, v251
    v_and_b32 v227, 0xffff0000, v251
    v_lshlrev_b32 v8, 16, v252
    v_pk_add_f32 v[212:213], v[212:213], v[8:9] op_sel_hi:[1,0]
    v_pk_add_f32 v[164:165], v[164:165], v[212:213]
    v_pk_add_f32 v[214:215], v[214:215], v[8:9] op_sel_hi:[1,0]
    v_pk_add_f32 v[166:167], v[166:167], v[214:215]
    v_pk_add_f32 v[216:217], v[216:217], v[8:9] op_sel_hi:[1,0]
    v_pk_add_f32 v[168:169], v[168:169], v[216:217]
    v_pk_add_f32 v[218:219], v[218:219], v[8:9] op_sel_hi:[1,0]
    v_pk_add_f32 v[170:171], v[170:171], v[218:219]
    v_pk_add_f32 v[220:221], v[220:221], v[8:9] op_sel_hi:[1,0]
    v_pk_add_f32 v[172:173], v[172:173], v[220:221]
    v_pk_add_f32 v[222:223], v[222:223], v[8:9] op_sel_hi:[1,0]
    v_pk_add_f32 v[174:175], v[174:175], v[222:223]
    v_pk_add_f32 v[224:225], v[224:225], v[8:9] op_sel_hi:[1,0]
    v_pk_add_f32 v[176:177], v[176:177], v[224:225]
    v_pk_add_f32 v[226:227], v[226:227], v[8:9] op_sel_hi:[1,0]
    v_pk_add_f32 v[178:179], v[178:179], v[226:227]
    s_mov_b32 s79, 3200000
lw_83:
    ds_read_b32 v5, v22 offset:16
    s_waitcnt lgkmcnt(0)
    v_readfirstlane_b32 s71, v5
    s_cmp_ge_u32 s71, 4
    s_cbranch_scc1 lwd_84
    s_sub_u32 s79, s79, 1
    s_cmp_lg_u32 s79, 0
    s_cbranch_scc1 lw_83
lwd_84:
    ds_read_b128 v[68:71], v255 offset:0
    ds_read_b128 v[84:87], v255 offset:16384
    ds_read_b128 v[100:103], v255 offset:32768
    ds_read_b128 v[72:75], v255 offset:1024
    ds_read_b128 v[88:91], v255 offset:17408
    ds_read_b128 v[104:107], v255 offset:33792
    ds_read_b128 v[76:79], v255 offset:2048
    ds_read_b128 v[92:95], v255 offset:18432
    ds_read_b128 v[108:111], v255 offset:34816
    ds_read_b128 v[80:83], v255 offset:3072
    ds_read_b128 v[96:99], v255 offset:19456
    ds_read_b128 v[112:115], v255 offset:35840
    s_waitcnt lgkmcnt(9)
    v_pk_add_f32 v[68:69], v[68:69], v[84:85]
    v_pk_add_f32 v[164:165], v[164:165], v[100:101]
    v_pk_add_f32 v[164:165], v[164:165], v[68:69]
    v_cvt_pk_bf16_f32 v36, v164, v165
    v_pk_add_f32 v[70:71], v[70:71], v[86:87]
    v_pk_add_f32 v[166:167], v[166:167], v[102:103]
    v_pk_add_f32 v[166:167], v[166:167], v[70:71]
    v_cvt_pk_bf16_f32 v37, v166, v167
    s_waitcnt lgkmcnt(6)
    v_pk_add_f32 v[72:73], v[72:73], v[88:89]
    v_pk_add_f32 v[168:169], v[168:169], v[104:105]
    v_pk_add_f32 v[168:169], v[168:169], v[72:73]
    v_cvt_pk_bf16_f32 v38, v168, v169
    v_pk_add_f32 v[74:75], v[74:75], v[90:91]
    v_pk_add_f32 v[170:171], v[170:171], v[106:107]
    v_pk_add_f32 v[170:171], v[170:171], v[74:75]
    v_cvt_pk_bf16_f32 v39, v170, v171
    v_permlane32_swap_b32 v36, v38
    s_nop 0
    v_permlane32_swap_b32 v37, v39
    buffer_store_dwordx4 v[36:39], v253, s[52:55], 0 offen offset:0
    s_waitcnt lgkmcnt(3)
    v_pk_add_f32 v[76:77], v[76:77], v[92:93]
    v_pk_add_f32 v[172:173], v[172:173], v[108:109]
    v_pk_add_f32 v[172:173], v[172:173], v[76:77]
    v_cvt_pk_bf16_f32 v40, v172, v173
    v_pk_add_f32 v[78:79], v[78:79], v[94:95]
    v_pk_add_f32 v[174:175], v[174:175], v[110:111]
    v_pk_add_f32 v[174:175], v[174:175], v[78:79]
    v_cvt_pk_bf16_f32 v41, v174, v175
    s_waitcnt lgkmcnt(0)
    v_pk_add_f32 v[80:81], v[80:81], v[96:97]
    v_pk_add_f32 v[176:177], v[176:177], v[112:113]
    v_pk_add_f32 v[176:177], v[176:177], v[80:81]
    v_cvt_pk_bf16_f32 v42, v176, v177
    v_pk_add_f32 v[82:83], v[82:83], v[98:99]
    v_pk_add_f32 v[178:179], v[178:179], v[114:115]
    v_pk_add_f32 v[178:179], v[178:179], v[82:83]
    v_cvt_pk_bf16_f32 v43, v178, v179
    v_permlane32_swap_b32 v40, v42
    s_nop 0
    v_permlane32_swap_b32 v41, v43
    buffer_store_dwordx4 v[40:43], v253, s[52:55], 0 offen offset:32
    s_branch L_done
L_attn:
    s_setprio 2
    s_barrier
    s_cmp_lg_u32 s28, 7
    s_cbranch_scc1 rs_85
    s_waitcnt vmcnt(0)
    s_mov_b32 s79, 400000
    s_branch tpc_88
tp_86:
    buffer_load_dwordx4 v[180:183], v184, s[56:59], s93 offen sc1
    s_waitcnt vmcnt(0)
tpc_88:
    v_xor_b32 v180, s99, v180
    v_xor_b32 v181, s99, v181
    v_xor_b32 v182, s99, v182
    v_xor_b32 v183, s99, v183
    v_or_b32 v180, v180, v181
    v_or_b32 v180, v180, v182
    v_or_b32 v180, v180, v183
    v_cmp_eq_u32 vcc, 0, v180
    s_cmp_eq_u64 vcc, exec
    s_cbranch_scc1 tpd_87
    s_sleep 4
    s_sub_u32 s79, s79, 1
    s_cmp_lg_u32 s79, 0
    s_cbranch_scc1 tp_86
tpd_87:
    v_mov_b32 v5, s99
    ds_write_b32 v22, v5 offset:20
rs_85:
    ds_read_b128 v[68:71], v24 offset:0
    ds_read_b128 v[72:75], v24 offset:1024
    ds_read_b128 v[76:79], v24 offset:2048
    ds_read_b128 v[80:83], v24 offset:3072
    ds_read_b128 v[84:87], v24 offset:4096
    ds_read_b128 v[88:91], v24 offset:5120
    ds_read_b128 v[92:95], v24 offset:6144
    ds_read_b128 v[96:99], v24 offset:7168
    ds_read_b128 v[100:103], v24 offset:8192
    ds_read_b128 v[104:107], v24 offset:9216
    ds_read_b128 v[108:111], v24 offset:10240
    ds_read_b128 v[112:115], v24 offset:11264
    s_waitcnt vmcnt(0)
    v_lshl_or_b32 v188, v27, 16, v26
    v_lshl_or_b32 v189, v29, 16, v28
    v_lshl_or_b32 v190, v31, 16, v30
    v_lshl_or_b32 v191, v33, 16, v32
    v_cmp_eq_u32 vcc, 0, v25
    s_nop 1
    v_cndmask_b32 v192, 0, v188, vcc
    v_cndmask_b32 v193, 0, v189, vcc
    v_cndmask_b32 v194, 0, v190, vcc
    v_cndmask_b32 v195, 0, v191, vcc
    v_cmp_ne_u32 vcc, 0, v25
    s_nop 1
    v_cndmask_b32 v196, 0, v188, vcc
    v_cndmask_b32 v197, 0, v189, vcc
    v_cndmask_b32 v198, 0, v190, vcc
    v_cndmask_b32 v199, 0, v191, vcc
    s_waitcnt lgkmcnt(0)
    v_pk_add_f32 v[132:133], v[132:133], v[68:69]
    v_pk_add_f32 v[134:135], v[134:135], v[70:71]
    v_pk_add_f32 v[136:137], v[136:137], v[72:73]
    v_pk_add_f32 v[138:139], v[138:139], v[74:75]
    v_pk_add_f32 v[140:141], v[140:141], v[76:77]
    v_pk_add_f32 v[142:143], v[142:143], v[78:79]
    v_pk_add_f32 v[144:145], v[144:145], v[80:81]
    v_pk_add_f32 v[146:147], v[146:147], v[82:83]
    v_pk_add_f32 v[148:149], v[148:149], v[84:85]
    v_pk_add_f32 v[150:151], v[150:151], v[86:87]
    v_pk_add_f32 v[152:153], v[152:153], v[88:89]
    v_pk_add_f32 v[154:155], v[154:155], v[90:91]
    v_pk_add_f32 v[156:157], v[156:157], v[92:93]
    v_pk_add_f32 v[158:159], v[158:159], v[94:95]
    v_pk_add_f32 v[160:161], v[160:161], v[96:97]
    v_pk_add_f32 v[162:163], v[162:163], v[98:99]
    v_pk_add_f32 v[164:165], v[164:165], v[100:101]
    v_pk_add_f32 v[166:167], v[166:167], v[102:103]
    v_pk_add_f32 v[168:169], v[168:169], v[104:105]
    v_pk_add_f32 v[170:171], v[170:171], v[106:107]
    v_pk_add_f32 v[172:173], v[172:173], v[108:109]
    v_pk_add_f32 v[174:175], v[174:175], v[110:111]
    v_pk_add_f32 v[176:177], v[176:177], v[112:113]
    v_pk_add_f32 v[178:179], v[178:179], v[114:115]
    v_cvt_pk_bf16_f32 v200, v148, v149
    v_cvt_pk_bf16_f32 v201, v150, v151
    v_cvt_pk_bf16_f32 v202, v152, v153
    v_cvt_pk_bf16_f32 v203, v154, v155
    v_cvt_pk_bf16_f32 v204, v156, v157
    v_cvt_pk_bf16_f32 v205, v158, v159
    v_cvt_pk_bf16_f32 v206, v160, v161
    v_cvt_pk_bf16_f32 v207, v162, v163
    v_mfma_f32_32x32x16_bf16 v[208:223], v[192:195], v[200:203], 0
    s_nop 0
    v_mfma_f32_32x32x16_bf16 v[208:223], v[196:199], v[204:207], v[208:223]
    s_nop 11
    v_max3_f32 v224, v208, v209, v210
    v_min3_f32 v225, v208, v209, v210
    v_max3_f32 v224, v224, v211, v212
    v_min3_f32 v225, v225, v211, v212
    v_max3_f32 v224, v224, v213, v214
    v_min3_f32 v225, v225, v213, v214
    v_max3_f32 v224, v224, v215, v216
    v_min3_f32 v225, v225, v215, v216
    v_max3_f32 v224, v224, v217, v218
    v_min3_f32 v225, v225, v217, v218
    v_max3_f32 v224, v224, v219, v220
    v_min3_f32 v225, v225, v219, v220
    v_max3_f32 v224, v224, v221, v222
    v_min3_f32 v225, v225, v221, v222
    v_max_f32 v224, v224, v223
    v_min_f32 v225, v225, v223
    v_mul_f32 v224, s76, v224
    v_mul_f32 v225, s76, v225
    v_fma_f32 v68, v208, s76, -v224
    v_fma_f32 v84, -v208, s76, v225
    v_fma_f32 v69, v209, s76, -v224
    v_fma_f32 v85, -v209, s76, v225
    v_fma_f32 v70, v210, s76, -v224
    v_fma_f32 v86, -v210, s76, v225
    v_fma_f32 v71, v211, s76, -v224
    v_fma_f32 v87, -v211, s76, v225
    v_fma_f32 v72, v212, s76, -v224
    v_fma_f32 v88, -v212, s76, v225
    v_fma_f32 v73, v213, s76, -v224
    v_fma_f32 v89, -v213, s76, v225
    v_fma_f32 v74, v214, s76, -v224
    v_fma_f32 v90, -v214, s76, v225
    v_fma_f32 v75, v215, s76, -v224
    v_fma_f32 v91, -v215, s76, v225
    v_fma_f32 v76, v216, s76, -v224
    v_fma_f32 v92, -v216, s76, v225
    v_fma_f32 v77, v217, s76, -v224
    v_fma_f32 v93, -v217, s76, v225
    v_fma_f32 v78, v218, s76, -v224
    v_fma_f32 v94, -v218, s76, v225
    v_fma_f32 v79, v219, s76, -v224
    v_fma_f32 v95, -v219, s76, v225
    v_fma_f32 v80, v220, s76, -v224
    v_fma_f32 v96, -v220, s76, v225
    v_fma_f32 v81, v221, s76, -v224
    v_fma_f32 v97, -v221, s76, v225
    v_fma_f32 v82, v222, s76, -v224
    v_fma_f32 v98, -v222, s76, v225
    v_fma_f32 v83, v223, s76, -v224
    v_fma_f32 v99, -v223, s76, v225
    v_exp_f32 v68, v68
    v_exp_f32 v69, v69
    v_exp_f32 v70, v70
    v_exp_f32 v71, v71
    v_exp_f32 v72, v72
    v_exp_f32 v73, v73
    v_exp_f32 v74, v74
    v_exp_f32 v75, v75
    v_exp_f32 v76, v76
    v_exp_f32 v77, v77
    v_exp_f32 v78, v78
    v_exp_f32 v79, v79
    v_exp_f32 v80, v80
    v_exp_f32 v81, v81
    v_exp_f32 v82, v82
    v_exp_f32 v83, v83
    v_exp_f32 v84, v84
    v_exp_f32 v85, v85
    v_exp_f32 v86, v86
    v_exp_f32 v87, v87
    v_exp_f32 v88, v88
    v_exp_f32 v89, v89
    v_exp_f32 v90, v90
    v_exp_f32 v91, v91
    v_exp_f32 v92, v92
    v_exp_f32 v93, v93
    v_exp_f32 v94, v94
    v_exp_f32 v95, v95
    v_exp_f32 v96, v96
    v_exp_f32 v97, v97
    v_exp_f32 v98, v98
    v_exp_f32 v99, v99
    v_pk_add_f32 v[208:209], v[68:69], v[70:71]
    v_pk_add_f32 v[210:211], v[72:73], v[74:75]
    v_pk_add_f32 v[212:213], v[76:77], v[78:79]
    v_pk_add_f32 v[214:215], v[80:81], v[82:83]
    v_pk_add_f32 v[208:209], v[208:209], v[210:211]
    v_pk_add_f32 v[212:213], v[212:213], v[214:215]
    v_pk_add_f32 v[208:209], v[208:209], v[212:213]
    v_add_f32 v208, v208, v209
    v_pk_add_f32 v[216:217], v[84:85], v[86:87]
    v_pk_add_f32 v[218:219], v[88:89], v[90:91]
    v_pk_add_f32 v[220:221], v[92:93], v[94:95]
    v_pk_add_f32 v[222:223], v[96:97], v[98:99]
    v_pk_add_f32 v[216:217], v[216:217], v[218:219]
    v_pk_add_f32 v[220:221], v[220:221], v[222:223]
    v_pk_add_f32 v[216:217], v[216:217], v[220:221]
    v_add_f32 v216, v216, v217
    v_rcp_f32 v228, v208
    v_rcp_f32 v230, v216
    v_pk_mul_f32 v[68:69], v[68:69], v[228:229] op_sel_hi:[1,0]
    v_pk_mul_f32 v[70:71], v[70:71], v[228:229] op_sel_hi:[1,0]
    v_pk_mul_f32 v[72:73], v[72:73], v[228:229] op_sel_hi:[1,0]
    v_pk_mul_f32 v[74:75], v[74:75], v[228:229] op_sel_hi:[1,0]
    v_pk_mul_f32 v[76:77], v[76:77], v[228:229] op_sel_hi:[1,0]
    v_pk_mul_f32 v[78:79], v[78:79], v[228:229] op_sel_hi:[1,0]
    v_pk_mul_f32 v[80:81], v[80:81], v[228:229] op_sel_hi:[1,0]
    v_pk_mul_f32 v[82:83], v[82:83], v[228:229] op_sel_hi:[1,0]
    v_cvt_pk_bf16_f32 v52, v68, v69
    v_cvt_pk_bf16_f32 v53, v70, v71
    v_cvt_pk_bf16_f32 v54, v72, v73
    v_cvt_pk_bf16_f32 v55, v74, v75
    v_cvt_pk_bf16_f32 v56, v76, v77
    v_cvt_pk_bf16_f32 v57, v78, v79
    v_cvt_pk_bf16_f32 v58, v80, v81
    v_cvt_pk_bf16_f32 v59, v82, v83
    v_pk_mul_f32 v[84:85], v[84:85], v[230:231] op_sel_hi:[1,0]
    v_pk_mul_f32 v[86:87], v[86:87], v[230:231] op_sel_hi:[1,0]
    v_pk_mul_f32 v[88:89], v[88:89], v[230:231] op_sel_hi:[1,0]
    v_pk_mul_f32 v[90:91], v[90:91], v[230:231] op_sel_hi:[1,0]
    v_pk_mul_f32 v[92:93], v[92:93], v[230:231] op_sel_hi:[1,0]
    v_pk_mul_f32 v[94:95], v[94:95], v[230:231] op_sel_hi:[1,0]
    v_pk_mul_f32 v[96:97], v[96:97], v[230:231] op_sel_hi:[1,0]
    v_pk_mul_f32 v[98:99], v[98:99], v[230:231] op_sel_hi:[1,0]
    v_cvt_pk_bf16_f32 v60, v84, v85
    v_cvt_pk_bf16_f32 v61, v86, v87
    v_cvt_pk_bf16_f32 v62, v88, v89
    v_cvt_pk_bf16_f32 v63, v90, v91
    v_cvt_pk_bf16_f32 v64, v92, v93
    v_cvt_pk_bf16_f32 v65, v94, v95
    v_cvt_pk_bf16_f32 v66, v96, v97
    v_cvt_pk_bf16_f32 v67, v98, v99
    v_and_b32 v5, 31, v4
    v_bfe_u32 v6, v5, 2, 1
    v_and_b32 v8, 1, v5
    v_lshl_or_b32 v6, v8, 1, v6
    v_bfe_u32 v8, v5, 1, 1
    v_lshl_or_b32 v6, v8, 2, v6
    s_add_u32 s69, s89, 81920
    v_lshlrev_b32 v9, 7, v5
    v_add_u32 v9, s69, v9
    v_lshl_add_u32 v8, v10, 2, 0
    v_xor_b32 v8, v8, v6
    v_lshl_add_u32 v8, v8, 4, v9
    ds_write_b128 v8, v[52:55]
    v_lshl_add_u32 v8, v10, 2, 1
    v_xor_b32 v8, v8, v6
    v_lshl_add_u32 v8, v8, 4, v9
    ds_write_b128 v8, v[56:59]
    v_lshl_add_u32 v8, v10, 2, 2
    v_xor_b32 v8, v8, v6
    v_lshl_add_u32 v8, v8, 4, v9
    ds_write_b128 v8, v[60:63]
    v_lshl_add_u32 v8, v10, 2, 3
    v_xor_b32 v8, v8, v6
    v_lshl_add_u32 v8, v8, 4, v9
    ds_write_b128 v8, v[64:67]
    v_cvt_pk_bf16_f32 v68, v164, v165
    v_cvt_pk_bf16_f32 v69, v166, v167
    v_cvt_pk_bf16_f32 v70, v168, v169
    v_cvt_pk_bf16_f32 v71, v170, v171
    v_cvt_pk_bf16_f32 v72, v172, v173
    v_cvt_pk_bf16_f32 v73, v174, v175
    v_cvt_pk_bf16_f32 v74, v176, v177
    v_cvt_pk_bf16_f32 v75, v178, v179
    v_bfe_u32 v8, v4, 4, 1
    v_mov_b32 v9, 0x3f803f80
    v_cmp_eq_u32 vcc, 0, v8
    s_nop 1
    v_cndmask_b32 v76, v9, v68, vcc
    v_cndmask_b32 v84, v68, v9, vcc
    v_cndmask_b32 v77, v9, v69, vcc
    v_cndmask_b32 v85, v69, v9, vcc
    v_cndmask_b32 v78, v9, v70, vcc
    v_cndmask_b32 v86, v70, v9, vcc
    v_cndmask_b32 v79, v9, v71, vcc
    v_cndmask_b32 v87, v71, v9, vcc
    v_cndmask_b32 v80, v9, v72, vcc
    v_cndmask_b32 v88, v72, v9, vcc
    v_cndmask_b32 v81, v9, v73, vcc
    v_cndmask_b32 v89, v73, v9, vcc
    v_cndmask_b32 v82, v9, v74, vcc
    v_cndmask_b32 v90, v74, v9, vcc
    v_cndmask_b32 v83, v9, v75, vcc
    v_cndmask_b32 v91, v75, v9, vcc
    v_lshl_add_u32 v5, v10, 2, v12
    v_bfe_u32 v6, v5, 2, 1
    v_and_b32 v8, 1, v5
    v_lshl_or_b32 v6, v8, 1, v6
    v_bfe_u32 v8, v5, 1, 1
    v_lshl_or_b32 v6, v8, 2, v6
    v_and_b32 v8, 1, v11
    v_lshrrev_b32 v9, 1, v13
    v_lshl_add_u32 v8, v8, 1, v9
    v_xor_b32 v8, v8, v6
    v_xor_b32 v6, 4, v8
    v_lshlrev_b32 v5, 7, v5
    v_and_b32 v9, 1, v13
    v_lshl_add_u32 v5, v9, 3, v5
    v_add_u32 v5, s69, v5
    v_lshl_add_u32 v8, v8, 4, v5
    v_lshl_add_u32 v6, v6, 4, v5
    s_waitcnt lgkmcnt(0)
    ds_read_b64_tr_b16 v[148:149], v8 offset:0
    ds_read_b64_tr_b16 v[150:151], v8 offset:1024
    ds_read_b64_tr_b16 v[152:153], v8 offset:2048
    ds_read_b64_tr_b16 v[154:155], v8 offset:3072
    ds_read_b64_tr_b16 v[156:157], v6 offset:0
    ds_read_b64_tr_b16 v[158:159], v6 offset:1024
    ds_read_b64_tr_b16 v[160:161], v6 offset:2048
    ds_read_b64_tr_b16 v[162:163], v6 offset:3072
    s_waitcnt lgkmcnt(0)
    v_mfma_f32_32x32x16_bf16 v[100:115], v[76:79], v[148:151], 0
    v_mfma_f32_32x32x16_bf16 v[100:115], v[80:83], v[152:155], v[100:115]
    v_mfma_f32_32x32x16_bf16 v[116:131], v[84:87], v[156:159], 0
    v_mfma_f32_32x32x16_bf16 v[116:131], v[88:91], v[160:163], v[116:131]
    s_and_b32 s64, s28, 1
    s_mul_i32 s64, s64, 6144
    s_add_u32 s64, s64, 148480
    v_add_u32 v232, s64, v14
    s_and_b32 s64, s28, 1
    s_lshl_b32 s64, s64, 2
    v_add_u32 v9, s64, v22
    s_bfe_u32 s64, s28, 0x10001
    s_cmp_eq_u32 s64, 0
    s_cbranch_scc1 L_a0
    ds_write_b128 v232, v[100:103] offset:0
    ds_write_b128 v232, v[104:107] offset:1024
    ds_write_b128 v232, v[108:111] offset:2048
    ds_write_b128 v232, v[124:127] offset:3072
    ds_write_b128 v232, v[128:131] offset:4096
    ds_write_b128 v232, v[116:119] offset:5120
    s_waitcnt lgkmcnt(0)
    s_mov_b64 exec, 1
    ds_add_u32 v9, v23 offset:4
    s_mov_b64 exec, -1
    s_waitcnt lgkmcnt(0)
    s_mov_b64 exec, 1
    ds_add_u32 v22, v23 offset:0
    s_mov_b64 exec, -1
    v_cvt_pk_bf16_f32 v200, v132, v133
    v_cvt_pk_bf16_f32 v201, v134, v135
    v_cvt_pk_bf16_f32 v202, v136, v137
    v_cvt_pk_bf16_f32 v203, v138, v139
    v_cvt_pk_bf16_f32 v204, v140, v141
    v_cvt_pk_bf16_f32 v205, v142, v143
    v_cvt_pk_bf16_f32 v206, v144, v145
    v_cvt_pk_bf16_f32 v207, v146, v147
    v_mfma_f32_32x32x16_bf16 v[208:223], v[192:195], v[200:203], 0
    s_nop 0
    v_mfma_f32_32x32x16_bf16 v[208:223], v[196:199], v[204:207], v[208:223]
    s_nop 11
    v_max3_f32 v224, v208, v209, v210
    v_min3_f32 v225, v208, v209, v210
    v_max3_f32 v224, v224, v211, v212
    v_min3_f32 v225, v225, v211, v212
    v_max3_f32 v224, v224, v213, v214
    v_min3_f32 v225, v225, v213, v214
    v_max3_f32 v224, v224, v215, v216
    v_min3_f32 v225, v225, v215, v216
    v_max3_f32 v224, v224, v217, v218
    v_min3_f32 v225, v225, v217, v218
    v_max3_f32 v224, v224, v219, v220
    v_min3_f32 v225, v225, v219, v220
    v_max3_f32 v224, v224, v221, v222
    v_min3_f32 v225, v225, v221, v222
    v_max_f32 v224, v224, v223
    v_min_f32 v225, v225, v223
    v_mul_f32 v224, s76, v224
    v_mul_f32 v225, s76, v225
    v_fma_f32 v68, v208, s76, -v224
    v_fma_f32 v84, -v208, s76, v225
    v_fma_f32 v69, v209, s76, -v224
    v_fma_f32 v85, -v209, s76, v225
    v_fma_f32 v70, v210, s76, -v224
    v_fma_f32 v86, -v210, s76, v225
    v_fma_f32 v71, v211, s76, -v224
    v_fma_f32 v87, -v211, s76, v225
    v_fma_f32 v72, v212, s76, -v224
    v_fma_f32 v88, -v212, s76, v225
    v_fma_f32 v73, v213, s76, -v224
    v_fma_f32 v89, -v213, s76, v225
    v_fma_f32 v74, v214, s76, -v224
    v_fma_f32 v90, -v214, s76, v225
    v_fma_f32 v75, v215, s76, -v224
    v_fma_f32 v91, -v215, s76, v225
    v_fma_f32 v76, v216, s76, -v224
    v_fma_f32 v92, -v216, s76, v225
    v_fma_f32 v77, v217, s76, -v224
    v_fma_f32 v93, -v217, s76, v225
    v_fma_f32 v78, v218, s76, -v224
    v_fma_f32 v94, -v218, s76, v225
    v_fma_f32 v79, v219, s76, -v224
    v_fma_f32 v95, -v219, s76, v225
    v_fma_f32 v80, v220, s76, -v224
    v_fma_f32 v96, -v220, s76, v225
    v_fma_f32 v81, v221, s76, -v224
    v_fma_f32 v97, -v221, s76, v225
    v_fma_f32 v82, v222, s76, -v224
    v_fma_f32 v98, -v222, s76, v225
    v_fma_f32 v83, v223, s76, -v224
    v_fma_f32 v99, -v223, s76, v225
    v_exp_f32 v68, v68
    v_exp_f32 v69, v69
    v_exp_f32 v70, v70
    v_exp_f32 v71, v71
    v_exp_f32 v72, v72
    v_exp_f32 v73, v73
    v_exp_f32 v74, v74
    v_exp_f32 v75, v75
    v_exp_f32 v76, v76
    v_exp_f32 v77, v77
    v_exp_f32 v78, v78
    v_exp_f32 v79, v79
    v_exp_f32 v80, v80
    v_exp_f32 v81, v81
    v_exp_f32 v82, v82
    v_exp_f32 v83, v83
    v_exp_f32 v84, v84
    v_exp_f32 v85, v85
    v_exp_f32 v86, v86
    v_exp_f32 v87, v87
    v_exp_f32 v88, v88
    v_exp_f32 v89, v89
    v_exp_f32 v90, v90
    v_exp_f32 v91, v91
    v_exp_f32 v92, v92
    v_exp_f32 v93, v93
    v_exp_f32 v94, v94
    v_exp_f32 v95, v95
    v_exp_f32 v96, v96
    v_exp_f32 v97, v97
    v_exp_f32 v98, v98
    v_exp_f32 v99, v99
    v_pk_add_f32 v[208:209], v[68:69], v[70:71]
    v_pk_add_f32 v[210:211], v[72:73], v[74:75]
    v_pk_add_f32 v[212:213], v[76:77], v[78:79]
    v_pk_add_f32 v[214:215], v[80:81], v[82:83]
    v_pk_add_f32 v[208:209], v[208:209], v[210:211]
    v_pk_add_f32 v[212:213], v[212:213], v[214:215]
    v_pk_add_f32 v[208:209], v[208:209], v[212:213]
    v_add_f32 v208, v208, v209
    v_pk_add_f32 v[216:217], v[84:85], v[86:87]
    v_pk_add_f32 v[218:219], v[88:89], v[90:91]
    v_pk_add_f32 v[220:221], v[92:93], v[94:95]
    v_pk_add_f32 v[222:223], v[96:97], v[98:99]
    v_pk_add_f32 v[216:217], v[216:217], v[218:219]
    v_pk_add_f32 v[220:221], v[220:221], v[222:223]
    v_pk_add_f32 v[216:217], v[216:217], v[220:221]
    v_add_f32 v216, v216, v217
    v_rcp_f32 v228, v208
    v_rcp_f32 v230, v216
    v_pk_mul_f32 v[68:69], v[68:69], v[228:229] op_sel_hi:[1,0]
    v_pk_mul_f32 v[70:71], v[70:71], v[228:229] op_sel_hi:[1,0]
    v_pk_mul_f32 v[72:73], v[72:73], v[228:229] op_sel_hi:[1,0]
    v_pk_mul_f32 v[74:75], v[74:75], v[228:229] op_sel_hi:[1,0]
    v_pk_mul_f32 v[76:77], v[76:77], v[228:229] op_sel_hi:[1,0]
    v_pk_mul_f32 v[78:79], v[78:79], v[228:229] op_sel_hi:[1,0]
    v_pk_mul_f32 v[80:81], v[80:81], v[228:229] op_sel_hi:[1,0]
    v_pk_mul_f32 v[82:83], v[82:83], v[228:229] op_sel_hi:[1,0]
    v_cvt_pk_bf16_f32 v36, v68, v69
    v_cvt_pk_bf16_f32 v37, v70, v71
    v_cvt_pk_bf16_f32 v38, v72, v73
    v_cvt_pk_bf16_f32 v39, v74, v75
    v_cvt_pk_bf16_f32 v40, v76, v77
    v_cvt_pk_bf16_f32 v41, v78, v79
    v_cvt_pk_bf16_f32 v42, v80, v81
    v_cvt_pk_bf16_f32 v43, v82, v83
    v_pk_mul_f32 v[84:85], v[84:85], v[230:231] op_sel_hi:[1,0]
    v_pk_mul_f32 v[86:87], v[86:87], v[230:231] op_sel_hi:[1,0]
    v_pk_mul_f32 v[88:89], v[88:89], v[230:231] op_sel_hi:[1,0]
    v_pk_mul_f32 v[90:91], v[90:91], v[230:231] op_sel_hi:[1,0]
    v_pk_mul_f32 v[92:93], v[92:93], v[230:231] op_sel_hi:[1,0]
    v_pk_mul_f32 v[94:95], v[94:95], v[230:231] op_sel_hi:[1,0]
    v_pk_mul_f32 v[96:97], v[96:97], v[230:231] op_sel_hi:[1,0]
    v_pk_mul_f32 v[98:99], v[98:99], v[230:231] op_sel_hi:[1,0]
    v_cvt_pk_bf16_f32 v44, v84, v85
    v_cvt_pk_bf16_f32 v45, v86, v87
    v_cvt_pk_bf16_f32 v46, v88, v89
    v_cvt_pk_bf16_f32 v47, v90, v91
    v_cvt_pk_bf16_f32 v48, v92, v93
    v_cvt_pk_bf16_f32 v49, v94, v95
    v_cvt_pk_bf16_f32 v50, v96, v97
    v_cvt_pk_bf16_f32 v51, v98, v99
    s_branch L_a1
L_a0:
    s_mov_b32 s79, 3200000
lw_89:
    ds_read_b32 v5, v9 offset:4
    s_waitcnt lgkmcnt(0)
    v_readfirstlane_b32 s71, v5
    s_cmp_ge_u32 s71, 1
    s_cbranch_scc1 lwd_90
    s_sleep 4
    s_sub_u32 s79, s79, 1
    s_cmp_lg_u32 s79, 0
    s_cbranch_scc1 lw_89
lwd_90:
    ds_read_b128 v[68:71], v232 offset:0
    ds_read_b128 v[72:75], v232 offset:1024
    ds_read_b128 v[76:79], v232 offset:2048
    ds_read_b128 v[80:83], v232 offset:3072
    ds_read_b128 v[84:87], v232 offset:4096
    ds_read_b128 v[88:91], v232 offset:5120
    s_waitcnt lgkmcnt(0)
    s_mov_b64 exec, 1
    ds_add_u32 v22, v23 offset:0
    s_mov_b64 exec, -1
    v_pk_add_f32 v[100:101], v[100:101], v[68:69]
    v_pk_add_f32 v[102:103], v[102:103], v[70:71]
    v_pk_add_f32 v[104:105], v[104:105], v[72:73]
    v_pk_add_f32 v[106:107], v[106:107], v[74:75]
    v_pk_add_f32 v[108:109], v[108:109], v[76:77]
    v_pk_add_f32 v[110:111], v[110:111], v[78:79]
    v_pk_add_f32 v[124:125], v[124:125], v[80:81]
    v_pk_add_f32 v[126:127], v[126:127], v[82:83]
    v_pk_add_f32 v[128:129], v[128:129], v[84:85]
    v_pk_add_f32 v[130:131], v[130:131], v[86:87]
    v_pk_add_f32 v[116:117], v[116:117], v[88:89]
    v_pk_add_f32 v[118:119], v[118:119], v[90:91]
    v_cvt_pk_bf16_f32 v148, v100, v101
    v_cvt_pk_bf16_f32 v152, v124, v125
    v_cvt_pk_bf16_f32 v149, v102, v103
    v_cvt_pk_bf16_f32 v153, v126, v127
    v_cvt_pk_bf16_f32 v150, v104, v105
    v_cvt_pk_bf16_f32 v154, v128, v129
    v_cvt_pk_bf16_f32 v151, v106, v107
    v_cvt_pk_bf16_f32 v155, v130, v131
    v_cmp_eq_u32 vcc, 0, v10
    s_nop 1
    v_cndmask_b32 v156, v116, v108, vcc
    s_lshl_b32 s64, s78, 5
    s_add_u32 s64, s64, s29
    s_mul_i32 s64, s64, 2560
    s_add_u32 s64, s64, 13631488
    v_lshlrev_b32 v5, 2, v4
    buffer_store_dwordx4 v[148:151], v14, s[56:59], s64 offen sc1
    buffer_store_dwordx4 v[152:155], v14, s[56:59], s64 offen offset:1024 sc1
    buffer_store_dword v156, v5, s[56:59], s64 offen offset:2048 sc1
    s_mov_b32 s79, 3200000
lw_91:
    ds_read_b32 v8, v22 offset:20
    s_waitcnt lgkmcnt(0)
    v_readfirstlane_b32 s71, v8
    s_cmp_ge_u32 s71, 1
    s_cbranch_scc1 lwd_92
    s_sleep 4
    s_sub_u32 s79, s79, 1
    s_cmp_lg_u32 s79, 0
    s_cbranch_scc1 lw_91
lwd_92:
    s_mov_b32 s99, s71
    s_waitcnt vmcnt(0)
    s_lshl_b32 s64, s78, 2
    s_lshr_b32 s65, s29, 3
    s_add_u32 s64, s64, s65
    s_lshl_b32 s64, s64, 7
    s_and_b32 s65, s29, 7
    s_lshl_b32 s65, s65, 2
    s_add_u32 s64, s64, s65
    s_add_u32 s64, s64, 12853248
    s_mov_b64 exec, 1
    v_mov_b32 v5, s99
    buffer_store_dword v5, v16, s[56:59], s64 offen sc1
    s_mov_b64 exec, -1
    v_cvt_pk_bf16_f32 v200, v132, v133
    v_cvt_pk_bf16_f32 v201, v134, v135
    v_cvt_pk_bf16_f32 v202, v136, v137
    v_cvt_pk_bf16_f32 v203, v138, v139
    v_cvt_pk_bf16_f32 v204, v140, v141
    v_cvt_pk_bf16_f32 v205, v142, v143
    v_cvt_pk_bf16_f32 v206, v144, v145
    v_cvt_pk_bf16_f32 v207, v146, v147
    v_mfma_f32_32x32x16_bf16 v[208:223], v[192:195], v[200:203], 0
    s_nop 0
    v_mfma_f32_32x32x16_bf16 v[208:223], v[196:199], v[204:207], v[208:223]
    s_nop 11
    v_max3_f32 v224, v208, v209, v210
    v_min3_f32 v225, v208, v209, v210
    v_max3_f32 v224, v224, v211, v212
    v_min3_f32 v225, v225, v211, v212
    v_max3_f32 v224, v224, v213, v214
    v_min3_f32 v225, v225, v213, v214
    v_max3_f32 v224, v224, v215, v216
    v_min3_f32 v225, v225, v215, v216
    v_max3_f32 v224, v224, v217, v218
    v_min3_f32 v225, v225, v217, v218
    v_max3_f32 v224, v224, v219, v220
    v_min3_f32 v225, v225, v219, v220
    v_max3_f32 v224, v224, v221, v222
    v_min3_f32 v225, v225, v221, v222
    v_max_f32 v224, v224, v223
    v_min_f32 v225, v225, v223
    v_mul_f32 v224, s76, v224
    v_mul_f32 v225, s76, v225
    v_fma_f32 v68, v208, s76, -v224
    v_fma_f32 v84, -v208, s76, v225
    v_fma_f32 v69, v209, s76, -v224
    v_fma_f32 v85, -v209, s76, v225
    v_fma_f32 v70, v210, s76, -v224
    v_fma_f32 v86, -v210, s76, v225
    v_fma_f32 v71, v211, s76, -v224
    v_fma_f32 v87, -v211, s76, v225
    v_fma_f32 v72, v212, s76, -v224
    v_fma_f32 v88, -v212, s76, v225
    v_fma_f32 v73, v213, s76, -v224
    v_fma_f32 v89, -v213, s76, v225
    v_fma_f32 v74, v214, s76, -v224
    v_fma_f32 v90, -v214, s76, v225
    v_fma_f32 v75, v215, s76, -v224
    v_fma_f32 v91, -v215, s76, v225
    v_fma_f32 v76, v216, s76, -v224
    v_fma_f32 v92, -v216, s76, v225
    v_fma_f32 v77, v217, s76, -v224
    v_fma_f32 v93, -v217, s76, v225
    v_fma_f32 v78, v218, s76, -v224
    v_fma_f32 v94, -v218, s76, v225
    v_fma_f32 v79, v219, s76, -v224
    v_fma_f32 v95, -v219, s76, v225
    v_fma_f32 v80, v220, s76, -v224
    v_fma_f32 v96, -v220, s76, v225
    v_fma_f32 v81, v221, s76, -v224
    v_fma_f32 v97, -v221, s76, v225
    v_fma_f32 v82, v222, s76, -v224
    v_fma_f32 v98, -v222, s76, v225
    v_fma_f32 v83, v223, s76, -v224
    v_fma_f32 v99, -v223, s76, v225
    v_exp_f32 v68, v68
    v_exp_f32 v69, v69
    v_exp_f32 v70, v70
    v_exp_f32 v71, v71
    v_exp_f32 v72, v72
    v_exp_f32 v73, v73
    v_exp_f32 v74, v74
    v_exp_f32 v75, v75
    v_exp_f32 v76, v76
    v_exp_f32 v77, v77
    v_exp_f32 v78, v78
    v_exp_f32 v79, v79
    v_exp_f32 v80, v80
    v_exp_f32 v81, v81
    v_exp_f32 v82, v82
    v_exp_f32 v83, v83
    v_exp_f32 v84, v84
    v_exp_f32 v85, v85
    v_exp_f32 v86, v86
    v_exp_f32 v87, v87
    v_exp_f32 v88, v88
    v_exp_f32 v89, v89
    v_exp_f32 v90, v90
    v_exp_f32 v91, v91
    v_exp_f32 v92, v92
    v_exp_f32 v93, v93
    v_exp_f32 v94, v94
    v_exp_f32 v95, v95
    v_exp_f32 v96, v96
    v_exp_f32 v97, v97
    v_exp_f32 v98, v98
    v_exp_f32 v99, v99
    v_pk_add_f32 v[208:209], v[68:69], v[70:71]
    v_pk_add_f32 v[210:211], v[72:73], v[74:75]
    v_pk_add_f32 v[212:213], v[76:77], v[78:79]
    v_pk_add_f32 v[214:215], v[80:81], v[82:83]
    v_pk_add_f32 v[208:209], v[208:209], v[210:211]
    v_pk_add_f32 v[212:213], v[212:213], v[214:215]
    v_pk_add_f32 v[208:209], v[208:209], v[212:213]
    v_add_f32 v208, v208, v209
    v_pk_add_f32 v[216:217], v[84:85], v[86:87]
    v_pk_add_f32 v[218:219], v[88:89], v[90:91]
    v_pk_add_f32 v[220:221], v[92:93], v[94:95]
    v_pk_add_f32 v[222:223], v[96:97], v[98:99]
    v_pk_add_f32 v[216:217], v[216:217], v[218:219]
    v_pk_add_f32 v[220:221], v[220:221], v[222:223]
    v_pk_add_f32 v[216:217], v[216:217], v[220:221]
    v_add_f32 v216, v216, v217
    v_rcp_f32 v228, v208
    v_rcp_f32 v230, v216
    v_pk_mul_f32 v[68:69], v[68:69], v[228:229] op_sel_hi:[1,0]
    v_pk_mul_f32 v[70:71], v[70:71], v[228:229] op_sel_hi:[1,0]
    v_pk_mul_f32 v[72:73], v[72:73], v[228:229] op_sel_hi:[1,0]
    v_pk_mul_f32 v[74:75], v[74:75], v[228:229] op_sel_hi:[1,0]
    v_pk_mul_f32 v[76:77], v[76:77], v[228:229] op_sel_hi:[1,0]
    v_pk_mul_f32 v[78:79], v[78:79], v[228:229] op_sel_hi:[1,0]
    v_pk_mul_f32 v[80:81], v[80:81], v[228:229] op_sel_hi:[1,0]
    v_pk_mul_f32 v[82:83], v[82:83], v[228:229] op_sel_hi:[1,0]
    v_cvt_pk_bf16_f32 v36, v68, v69
    v_cvt_pk_bf16_f32 v37, v70, v71
    v_cvt_pk_bf16_f32 v38, v72, v73
    v_cvt_pk_bf16_f32 v39, v74, v75
    v_cvt_pk_bf16_f32 v40, v76, v77
    v_cvt_pk_bf16_f32 v41, v78, v79
    v_cvt_pk_bf16_f32 v42, v80, v81
    v_cvt_pk_bf16_f32 v43, v82, v83
    v_pk_mul_f32 v[84:85], v[84:85], v[230:231] op_sel_hi:[1,0]
    v_pk_mul_f32 v[86:87], v[86:87], v[230:231] op_sel_hi:[1,0]
    v_pk_mul_f32 v[88:89], v[88:89], v[230:231] op_sel_hi:[1,0]
    v_pk_mul_f32 v[90:91], v[90:91], v[230:231] op_sel_hi:[1,0]
    v_pk_mul_f32 v[92:93], v[92:93], v[230:231] op_sel_hi:[1,0]
    v_pk_mul_f32 v[94:95], v[94:95], v[230:231] op_sel_hi:[1,0]
    v_pk_mul_f32 v[96:97], v[96:97], v[230:231] op_sel_hi:[1,0]
    v_pk_mul_f32 v[98:99], v[98:99], v[230:231] op_sel_hi:[1,0]
    v_cvt_pk_bf16_f32 v44, v84, v85
    v_cvt_pk_bf16_f32 v45, v86, v87
    v_cvt_pk_bf16_f32 v46, v88, v89
    v_cvt_pk_bf16_f32 v47, v90, v91
    v_cvt_pk_bf16_f32 v48, v92, v93
    v_cvt_pk_bf16_f32 v49, v94, v95
    v_cvt_pk_bf16_f32 v50, v96, v97
    v_cvt_pk_bf16_f32 v51, v98, v99
L_a1:
    s_cmp_lg_u32 s28, 7
    s_cbranch_scc1 p2_93
    s_lshl_b32 s67, s30, 7
    s_add_u32 s67, s67, 12881920
    s_mov_b32 s79, 3200000
lw_94:
    ds_read_b32 v5, v22 offset:48
    s_waitcnt lgkmcnt(0)
    v_readfirstlane_b32 s71, v5
    s_cmp_ge_u32 s71, 1
    s_cbranch_scc1 lwd_95
    s_sleep 4
    s_sub_u32 s79, s79, 1
    s_cmp_lg_u32 s79, 0
    s_cbranch_scc1 lw_94
lwd_95:
    s_mov_b32 s79, 400000
tp_96:
    buffer_load_dword v180, v16, s[56:59], s67 offen sc1
    s_waitcnt vmcnt(0)
tpc_98:
    v_xor_b32 v180, s99, v180
    v_cmp_eq_u32 vcc, 0, v180
    s_cmp_eq_u64 vcc, exec
    s_cbranch_scc1 tpd_97
    s_sleep 12
    s_sub_u32 s79, s79, 1
    s_cmp_lg_u32 s79, 0
    s_cbranch_scc1 tp_96
tpd_97:
    v_mov_b32 v5, s99
    ds_write_b32 v22, v5 offset:24
p2_93:
    v_mov_b32 v132, 0
    v_mov_b32 v133, 0
    v_mov_b32 v134, 0
    v_mov_b32 v135, 0
    v_mov_b32 v136, 0
    v_mov_b32 v137, 0
    v_mov_b32 v138, 0
    v_mov_b32 v139, 0
    v_mov_b32 v140, 0
    v_mov_b32 v141, 0
    v_mov_b32 v142, 0
    v_mov_b32 v143, 0
    v_mov_b32 v144, 0
    v_mov_b32 v145, 0
    v_mov_b32 v146, 0
    v_mov_b32 v147, 0
    v_mov_b32 v148, 0
    v_mov_b32 v149, 0
    v_mov_b32 v150, 0
    v_mov_b32 v151, 0
    v_mov_b32 v152, 0
    v_mov_b32 v153, 0
    v_mov_b32 v154, 0
    v_mov_b32 v155, 0
    v_mov_b32 v156, 0
    v_mov_b32 v157, 0
    v_mov_b32 v158, 0
    v_mov_b32 v159, 0
    v_mov_b32 v160, 0
    v_mov_b32 v161, 0
    v_mov_b32 v162, 0
    v_mov_b32 v163, 0
    v_bfe_u32 v8, v4, 4, 1
    v_and_b32 v6, 31, v4
    v_lshlrev_b32 v6, 4, v6
    v_lshlrev_b32 v9, 6, v8
    s_lshl_b32 s64, s78, 12
    s_add_u32 s64, s64, 13107200
    s_mov_b32 s79, 3200000
lw_99:
    ds_read_b32 v5, v22 offset:24
    s_waitcnt lgkmcnt(0)
    v_readfirstlane_b32 s71, v5
    s_cmp_ge_u32 s71, 1
    s_cbranch_scc1 lwd_100
    s_sleep 4
    s_sub_u32 s79, s79, 1
    s_cmp_lg_u32 s79, 0
    s_cbranch_scc1 lw_99
lwd_100:
    s_mov_b32 s99, s71
    v_cmp_eq_u32 vcc, v8, v10
    s_and_saveexec_b64 s[68:69], vcc
    buffer_load_dwordx4 v[132:135], v6, s[56:59], s64 offen offset:0 sc1
    buffer_load_dwordx4 v[148:151], v9, s[56:59], s64 offen offset:2048 sc1
    buffer_load_dwordx4 v[136:139], v6, s[56:59], s64 offen offset:512 sc1
    buffer_load_dwordx4 v[152:155], v9, s[56:59], s64 offen offset:2064 sc1
    buffer_load_dwordx4 v[140:143], v6, s[56:59], s64 offen offset:1024 sc1
    buffer_load_dwordx4 v[156:159], v9, s[56:59], s64 offen offset:2080 sc1
    buffer_load_dwordx4 v[144:147], v6, s[56:59], s64 offen offset:1536 sc1
    buffer_load_dwordx4 v[160:163], v9, s[56:59], s64 offen offset:2096 sc1
    s_mov_b64 exec, -1
    s_waitcnt vmcnt(0)
    v_mfma_f32_32x32x16_bf16 v[68:83], v[132:135], v[36:39], 0
    v_mfma_f32_32x32x16_bf16 v[68:83], v[136:139], v[40:43], v[68:83]
    v_mfma_f32_32x32x16_bf16 v[68:83], v[140:143], v[44:47], v[68:83]
    v_mfma_f32_32x32x16_bf16 v[68:83], v[144:147], v[48:51], v[68:83]
    v_mfma_f32_32x32x16_bf16 v[100:115], v[148:151], v[36:39], 0
    v_mfma_f32_32x32x16_bf16 v[100:115], v[152:155], v[40:43], v[100:115]
    v_mfma_f32_32x32x16_bf16 v[100:115], v[156:159], v[44:47], v[100:115]
    v_mfma_f32_32x32x16_bf16 v[100:115], v[160:163], v[48:51], v[100:115]
    s_nop 11
    v_add_f32 v84, 0x358637bd, v100
    v_rcp_f32 v84, v84
    v_add_f32 v86, 0x358637bd, v108
    v_rcp_f32 v86, v86
    v_pk_mul_f32 v[68:69], v[68:69], v[84:85] op_sel_hi:[1,0]
    v_cvt_pk_bf16_f32 v164, v68, v69
    v_pk_mul_f32 v[70:71], v[70:71], v[84:85] op_sel_hi:[1,0]
    v_cvt_pk_bf16_f32 v165, v70, v71
    v_pk_mul_f32 v[72:73], v[72:73], v[84:85] op_sel_hi:[1,0]
    v_cvt_pk_bf16_f32 v166, v72, v73
    v_pk_mul_f32 v[74:75], v[74:75], v[84:85] op_sel_hi:[1,0]
    v_cvt_pk_bf16_f32 v167, v74, v75
    v_pk_mul_f32 v[76:77], v[76:77], v[86:87] op_sel_hi:[1,0]
    v_cvt_pk_bf16_f32 v168, v76, v77
    v_pk_mul_f32 v[78:79], v[78:79], v[86:87] op_sel_hi:[1,0]
    v_cvt_pk_bf16_f32 v169, v78, v79
    v_pk_mul_f32 v[80:81], v[80:81], v[86:87] op_sel_hi:[1,0]
    v_cvt_pk_bf16_f32 v170, v80, v81
    v_pk_mul_f32 v[82:83], v[82:83], v[86:87] op_sel_hi:[1,0]
    v_cvt_pk_bf16_f32 v171, v82, v83
    s_lshl_b32 s64, s78, 17
    s_bfe_u32 s65, s28, 0x10001
    s_lshl_b32 s66, s29, 1
    s_add_u32 s65, s65, s66
    s_lshl_b32 s65, s65, 10
    s_add_u32 s64, s64, s65
    s_add_u32 s64, s64, 8388608
    s_add_u32 s65, s64, 65536
    buffer_store_dwordx4 v[164:167], v14, s[56:59], s64 offen sc1
    buffer_store_dwordx4 v[168:171], v14, s[56:59], s65 offen sc1
    s_lshl_b32 s64, s29, 7
    s_lshl_b32 s65, s30, 2
    s_add_u32 s64, s64, s65
    s_add_u32 s64, s64, 12865536
    s_waitcnt vmcnt(0)
    s_mov_b64 exec, 1
    ds_add_rtn_u32 v5, v22, v23 offset:44
    s_waitcnt lgkmcnt(0)
    v_readfirstlane_b32 s65, v5
    s_cmp_lg_u32 s65, 3
    s_cbranch_scc1 f3_101
    s_mov_b64 exec, 1
    v_mov_b32 v5, s99
    buffer_store_dword v5, v16, s[56:59], s64 offen sc1
    s_mov_b64 exec, -1
f3_101:
    s_mov_b64 exec, -1
    s_cmp_lg_u32 s28, 6
    s_cbranch_scc1 p4_102
    s_mul_i32 s64, s34, 86
    s_lshr_b32 s64, s64, 6
    s_mul_i32 s66, s64, 384
    s_add_u32 s66, s66, 12873728
    v_and_b32 v5, 31, v4
    v_min_u32 v5, 21, v5
    v_lshrrev_b32 v6, 3, v5
    v_mad_u32_u24 v6, v10, 3, v6
    v_and_b32 v5, 7, v5
    v_lshlrev_b32 v5, 2, v5
    v_lshl_add_u32 v6, v6, 7, v5
    s_mov_b32 s79, 3200000
lw_103:
    ds_read_b32 v5, v22 offset:56
    s_waitcnt lgkmcnt(0)
    v_readfirstlane_b32 s71, v5
    s_cmp_ge_u32 s71, 1
    s_cbranch_scc1 lwd_104
    s_sleep 4
    s_sub_u32 s79, s79, 1
    s_cmp_lg_u32 s79, 0
    s_cbranch_scc1 lw_103
lwd_104:
    s_mov_b32 s79, 400000
tp_105:
    buffer_load_dword v180, v6, s[56:59], s66 offen sc1
    s_waitcnt vmcnt(0)
tpc_107:
    v_xor_b32 v180, s99, v180
    v_cmp_eq_u32 vcc, 0, v180
    s_cmp_eq_u64 vcc, exec
    s_cbranch_scc1 tpd_106
    s_sleep 4
    s_sub_u32 s79, s79, 1
    s_cmp_lg_u32 s79, 0
    s_cbranch_scc1 tp_105
tpd_106:
    s_waitcnt lgkmcnt(0)
    s_mov_b64 exec, 1
    ds_add_u32 v22, v23 offset:32
    s_mov_b64 exec, -1
    s_waitcnt lgkmcnt(0)
p4_102:
    s_cmp_lg_u32 s28, 7
    s_cbranch_scc1 p3_108
    v_and_b32 v5, 7, v4
    v_lshlrev_b32 v6, 2, v5
    s_lshl_b32 s67, s33, 7
    s_add_u32 s67, s67, 12865536
    s_mov_b32 s79, 3200000
lw_109:
    ds_read_b32 v5, v22 offset:32
    s_waitcnt lgkmcnt(0)
    v_readfirstlane_b32 s71, v5
    s_cmp_ge_u32 s71, 1
    s_cbranch_scc1 lwd_110
    s_sleep 8
    s_sub_u32 s79, s79, 1
    s_cmp_lg_u32 s79, 0
    s_cbranch_scc1 lw_109
lwd_110:
    s_mov_b32 s79, 400000
tp_111:
    buffer_load_dword v180, v6, s[56:59], s67 offen sc1
    s_waitcnt vmcnt(0)
tpc_113:
    v_xor_b32 v180, s99, v180
    v_cmp_eq_u32 vcc, 0, v180
    s_cmp_eq_u64 vcc, exec
    s_cbranch_scc1 tpd_112
    s_sleep 8
    s_sub_u32 s79, s79, 1
    s_cmp_lg_u32 s79, 0
    s_cbranch_scc1 tp_111
tpd_112:
    s_waitcnt lgkmcnt(0)
    s_mov_b64 exec, 1
    ds_add_u32 v22, v23 offset:28
    s_mov_b64 exec, -1
    s_waitcnt lgkmcnt(0)
p3_108:
L_done:
    s_endpgm
.p2align 3
L_table:
.long 0x200, 0x0
.long 0x2002c0, 0x2b0000
.long 0x20206, 0x300
.long 0x2202c6, 0x2b0300
.long 0x4020c, 0x600
.long 0x2402cc, 0x2b0600
.long 0x60211, 0x880
.long 0x2602d1, 0x2b0880
.long 0x3404e20, 0x15800
.long 0x3604ee0, 0x2c5800
.long 0x3424e26, 0x15b00
.long 0x3624ee6, 0x2c5b00
.long 0x3444e2c, 0x15e00
.long 0x3644eec, 0x2c5e00
.long 0x3464e31, 0x16080
.long 0x3664ef1, 0x2c6080
.long 0x6809640, 0x2b000
.long 0x6a09700, 0x2db000
.long 0x6829646, 0x2b300
.long 0x6a29706, 0x2db300
.long 0x684964c, 0x2b600
.long 0x6a4970c, 0x2db600
.long 0x6869651, 0x2b880
.long 0x6a69711, 0x2db880
.long 0x9c0e260, 0x40800
.long 0x9e0e320, 0x2f0800
.long 0x9c2e266, 0x40b00
.long 0x9e2e326, 0x2f0b00
.long 0x9c4e26c, 0x40e00
.long 0x9e4e32c, 0x2f0e00
.long 0x9c6e271, 0x41080
.long 0x9e6e331, 0x2f1080
.long 0x1012e80, 0x56000
.long 0x1212f40, 0x306000
.long 0x1032e86, 0x56300
.long 0x1232f46, 0x306300
.long 0x1052e8c, 0x56600
.long 0x1252f4c, 0x306600
.long 0x1072e91, 0x56880
.long 0x1272f51, 0x306880
.long 0x44176a0, 0x6b800
.long 0x4614ec1, 0x31b800
.long 0x44376a6, 0x6bb00
.long 0x4634ec7, 0x31bb00
.long 0x44576ac, 0x6be00
.long 0x4654ecd, 0x31be00
.long 0x44776b1, 0x6c080
.long 0x4674ed2, 0x31c080
.long 0x7818e01, 0x81000
.long 0x7a196e1, 0x331000
.long 0x7838e07, 0x81300
.long 0x7a396e7, 0x331300
.long 0x7858e0d, 0x81600
.long 0x7a596ed, 0x331600
.long 0x7878e12, 0x81880
.long 0x7a796f2, 0x331880
.long 0xac1d621, 0x96800
.long 0xae1e301, 0x346800
.long 0xac3d627, 0x96b00
.long 0xae3e307, 0x346b00
.long 0xac5d62d, 0x96e00
.long 0xae5e30d, 0x346e00
.long 0xac7d632, 0x97080
.long 0xae7e312, 0x347080
.long 0x5482241, 0xac000
.long 0x5682f21, 0x35c000
.long 0x54a2247, 0xac300
.long 0x56a2f27, 0x35c300
.long 0x54c224d, 0xac600
.long 0x56c2f2d, 0x35c600
.long 0x54e2252, 0xac880
.long 0x56e2f32, 0x35c880
.long 0x8886e61, 0xc1800
.long 0x8a87741, 0x371800
.long 0x88a6e67, 0xc1b00
.long 0x8aa7747, 0x371b00
.long 0x88c6e6d, 0xc1e00
.long 0x8ac774d, 0x371e00
.long 0x88e6e72, 0xc2080
.long 0x8ae7752, 0x372080
.long 0xc8b681, 0xd7000
.long 0xe896c2, 0x387000
.long 0xcab687, 0xd7300
.long 0xea96c8, 0x387300
.long 0xccb68d, 0xd7600
.long 0xec96ce, 0x387600
.long 0xceb692, 0xd7880
.long 0xee96d3, 0x387880
.long 0x308c2a1, 0xec800
.long 0x328e2e2, 0x39c800
.long 0x30ac2a7, 0xecb00
.long 0x32ae2e8, 0x39cb00
.long 0x30cc2ad, 0xece00
.long 0x32ce2ee, 0x39ce00
.long 0x30ec2b2, 0xed080
.long 0x32ee2f3, 0x39d080
.long 0x6491602, 0x102000
.long 0x6692f02, 0x3b2000
.long 0x64b1608, 0x102300
.long 0x66b2f08, 0x3b2300
.long 0x64d160e, 0x102600
.long 0x66d2f0e, 0x3b2600
.long 0x64f1613, 0x102880
.long 0x66f2f13, 0x3b2880
.long 0x9896222, 0x117800
.long 0x9a97722, 0x3c7800
.long 0x98b6228, 0x117b00
.long 0x9ab7728, 0x3c7b00
.long 0x98d622e, 0x117e00
.long 0x9ad772e, 0x3c7e00
.long 0x98f6233, 0x118080
.long 0x9af7733, 0x3c8080
.long 0x1c9ae42, 0x12d000
.long 0x1e98342, 0x3dd000
.long 0x1cbae48, 0x12d300
.long 0x1eb8348, 0x3dd300
.long 0x1cdae4e, 0x12d600
.long 0x1ed834e, 0x3dd600
.long 0x1cfae53, 0x12d880
.long 0x1ef8353, 0x3dd880
.long 0x409f662, 0x142800
.long 0x429e2c3, 0x3f2800
.long 0x40bf668, 0x142b00
.long 0x42be2c9, 0x3f2b00
.long 0x40df66e, 0x142e00
.long 0x42de2cf, 0x3f2e00
.long 0x40ff673, 0x143080
.long 0x42fe2d4, 0x3f3080
.long 0xa900282, 0x158000
.long 0xab02ee3, 0x408000
.long 0xa920288, 0x158300
.long 0xab22ee9, 0x408300
.long 0xa94028e, 0x158600
.long 0xab42eef, 0x408600
.long 0xa960293, 0x158880
.long 0xab62ef4, 0x408880
.long 0x2d04ea2, 0x16d800
.long 0x2f07703, 0x41d800
.long 0x2d24ea8, 0x16db00
.long 0x2f27709, 0x41db00
.long 0x2d44eae, 0x16de00
.long 0x2f4770f, 0x41de00
.long 0x2d64eb3, 0x16e080
.long 0x2f67714, 0x41e080
.long 0x510a203, 0x183000
.long 0x5308323, 0x433000
.long 0x512a209, 0x183300
.long 0x5328329, 0x433300
.long 0x514a20f, 0x183600
.long 0x534832f, 0x433600
.long 0x516a214, 0x183880
.long 0x5368334, 0x433880
.long 0x850ee23, 0x198800
.long 0x870cf43, 0x448800
.long 0x852ee29, 0x198b00
.long 0x872cf49, 0x448b00
.long 0x854ee2f, 0x198e00
.long 0x874cf4f, 0x448e00
.long 0x856ee34, 0x199080
.long 0x876cf54, 0x449080
.long 0x913643, 0x1ae000
.long 0xb12ec4, 0x45e000
.long 0x933649, 0x1ae300
.long 0xb32eca, 0x45e300
.long 0x95364f, 0x1ae600
.long 0xb52ed0, 0x45e600
.long 0x973654, 0x1ae880
.long 0xb72ed5, 0x45e880
.long 0x3d14263, 0x1c3800
.long 0x3f176e4, 0x473800
.long 0x3d34269, 0x1c3b00
.long 0x3f376ea, 0x473b00
.long 0x3d5426f, 0x1c3e00
.long 0x3f576f0, 0x473e00
.long 0x3d74274, 0x1c4080
.long 0x3f776f5, 0x474080
.long 0x6118e83, 0x1d9000
.long 0x6318304, 0x489000
.long 0x6138e89, 0x1d9300
.long 0x633830a, 0x489300
.long 0x6158e8f, 0x1d9600
.long 0x6358310, 0x489600
.long 0x6178e94, 0x1d9880
.long 0x6378315, 0x489880
.long 0x951d6a3, 0x1ee800
.long 0x971cf24, 0x49e800
.long 0x953d6a9, 0x1eeb00
.long 0x973cf2a, 0x49eb00
.long 0x955d6af, 0x1eee00
.long 0x975cf30, 0x49ee00
.long 0x957d6b4, 0x1ef080
.long 0x977cf35, 0x49f080
.long 0x4d82e04, 0x204000
.long 0x4f81744, 0x4b4000
.long 0x4da2e0a, 0x204300
.long 0x4fa174a, 0x4b4300
.long 0x4dc2e10, 0x204600
.long 0x4fc1750, 0x4b4600
.long 0x4de2e15, 0x204880
.long 0x4fe1755, 0x4b4880
.long 0x7187624, 0x219800
.long 0x73876c5, 0x4c9800
.long 0x71a762a, 0x219b00
.long 0x73a76cb, 0x4c9b00
.long 0x71c7630, 0x219e00
.long 0x73c6eab, 0x4c9e00
.long 0x71e7635, 0x21a080
.long 0x73e6ea5, 0x4ca080
.long 0xa588244, 0x22f000
.long 0xa7882e5, 0x4df000
.long 0xa5a824a, 0x22f300
.long 0xa7a82eb, 0x4df300
.long 0xa5c8250, 0x22f600
.long 0xa7ca28b, 0x4df600
.long 0xa5e8255, 0x22f880
.long 0xa7ea285, 0x4df880
.long 0x298ce64, 0x244800
.long 0x2b8cf05, 0x4f4800
.long 0x29ace6a, 0x244b00
.long 0x2bacf0b, 0x4f4b00
.long 0x29cce70, 0x244e00
.long 0x2bcd66b, 0x4f4e00
.long 0x29ece75, 0x245080
.long 0x2bed665, 0x4f5080
.long 0x5d91684, 0x25a000
.long 0x5f91725, 0x50a000
.long 0x5db168a, 0x25a300
.long 0x5fb172b, 0x50a300
.long 0x5dd1690, 0x25a600
.long 0x5fd0e4b, 0x50a600
.long 0x5df1695, 0x25a880
.long 0x5ff0e45, 0x50a880
.long 0x81962a4, 0x26f800
.long 0x8396345, 0x51f800
.long 0x81b62aa, 0x26fb00
.long 0x83b634b, 0x51fb00
.long 0x81d62b0, 0x26fe00
.long 0x83d4000, 0x51fe00
.long 0x81f62b5, 0x270080
.long 0x83f4020, 0x520080
.long 0x59b605, 0x285000
.long 0x798040, 0x535000
.long 0x5bb60b, 0x285300
.long 0x7b8060, 0x535300
.long 0x5d8080, 0x285600
.long 0x7d80a0, 0x535600
.long 0x5f80c0, 0x285880
.long 0x7f80e0, 0x535880
.long 0x399c225, 0x29a800
.long 0x3b9c100, 0x54a800
.long 0x39bc22b, 0x29ab00
.long 0x3bbc120, 0x54ab00
.long 0x39dc140, 0x29ae00
.long 0x3bdc160, 0x54ae00
.long 0x39fc180, 0x29b080
.long 0x3bfc1a0, 0x54b080

.section .rodata,"a"
.p2align 6
.amdhsa_kernel parallel_sum__linear_kernel_hedgehog__mixer_token_mlp__prompt_kernel
  .amdhsa_next_free_vgpr 256
  .amdhsa_next_free_sgpr 102
  .amdhsa_accum_offset 256
  .amdhsa_group_segment_fixed_size 0
  .amdhsa_kernarg_size 96
  .amdhsa_user_sgpr_count 2
  .amdhsa_user_sgpr_kernarg_segment_ptr 1
  .amdhsa_system_sgpr_workgroup_id_x 1
.end_amdhsa_kernel
```
